```python
import torch

def _softmax(x, axis=-1):
    return torch.softmax(x, dim=axis)
def _gelu(x):
    return torch.nn.functional.gelu(x, approximate="tanh")
def _silu(x):
    return torch.nn.functional.silu(x)
def _sigmoid(x):
    return torch.sigmoid(x)
def _layernorm(x, axis=-1, eps=1e-5):
    m = x.mean(dim=axis, keepdim=True)
    v = x.var(dim=axis, keepdim=True, unbiased=False)
    return (x - m) / torch.sqrt(v + eps)
def _scatter_add(tgt, idx, src, axis=0):
    return tgt.clone().index_add_(axis, idx, src)
def _segment_sum(src, seg, n):
    out = torch.zeros((n,) + src.shape[1:], dtype=src.dtype)
    return out.index_add_(0, seg, src)
def _pad(x, pw):
    flat = tuple(v for pair in reversed(pw) for v in pair)
    return torch.nn.functional.pad(x, flat)

kernel_name = 'parallel_sum__spectral_gfnet__glu_gated_swiglu__prompt'

def setup_inputs():

    _w = (lambda a: (lambda t: t.to(torch.bfloat16) if t.is_floating_point() else t)(torch.as_tensor(a)))
    def _A_setup():
        B, S, D = 1, 2048, 448
        Df = D // 2 + 1
        return {
            "x": _w((lambda *s: torch.randn(*s, dtype=torch.bfloat16) * 0.05)(B, S, D)),
            "w_r": _w((lambda *s: torch.randn(*s, dtype=torch.bfloat16) * 0.4)(S, Df) * 0.02),
            "w_i": _w((lambda *s: torch.randn(*s, dtype=torch.bfloat16) * 0.4)(S, Df) * 0.02),
        }
    _A_in = _A_setup()

    def _B_setup():
        B, S, D, F = 1, 2048, 448, 1792
        return {
            "x": _w((lambda *s: torch.randn(*s, dtype=torch.bfloat16) * 0.05)(B, S, D)),
            "w1": _w((lambda *s: torch.randn(*s, dtype=torch.bfloat16) * 0.2)(D, F) * (2.0 / D) ** 0.5),
            "w3": _w((lambda *s: torch.randn(*s, dtype=torch.bfloat16) * 0.2)(D, F) * (2.0 / D) ** 0.5),
            "w2": _w((lambda *s: torch.randn(*s, dtype=torch.bfloat16) * 0.2)(F, D) * (2.0 / F) ** 0.5),
        }
    _B_in = _B_setup()

    return {
        "A_x": _A_in["x"],
        "A_w_r": _A_in["w_r"],
        "A_w_i": _A_in["w_i"],
        "B_x": _B_in["x"],
        "B_w1": _B_in["w1"],
        "B_w3": _B_in["w3"],
        "B_w2": _B_in["w2"],
    }

def reference(A_x, A_w_r, A_w_i, B_x, B_w1, B_w3, B_w2):
    def _A_ref(x, w_r, w_i):
        B, S, D = x.shape
        X = (lambda x, axes=(-2,-1): torch.fft.rfft2(x.float(), dim=axes))(x, axes=(-2, -1))
        W = w_r + 1j * w_i
        X = X * W
        y = (lambda x, s, axes=(-2,-1): torch.fft.irfft2(x, s=s, dim=axes).to(torch.bfloat16))(X, (S, D), axes=(-2, -1))
        return y

    def _B_ref(x, w1, w3, w2):
        gate = torch.einsum("bsd,df->bsf", x, w1)
        up = torch.einsum("bsd,df->bsf", x, w3)
        h = _silu(gate) * up
        out = torch.einsum("bsf,fd->bsd", h, w2)
        return out

    x = A_x
    xn = _layernorm(x, axis=-1)
    return x + _A_ref(xn, A_w_r, A_w_i) + _B_ref(xn, B_w1, B_w3, B_w2)
```

```asm
; @launch grid=(256,1,1) block=(256,1,1) lds=163840
.amdgcn_target "amdgcn-amd-amdhsa--gfx950"
.text
.globl parallel_sum__spectral_gfnet__glu_gated_swiglu__prompt_kernel
.p2align 12
.type parallel_sum__spectral_gfnet__glu_gated_swiglu__prompt_kernel,@function
parallel_sum__spectral_gfnet__glu_gated_swiglu__prompt_kernel:
    s_load_dwordx2 s[8:9], s[0:1], 0
    s_load_dwordx4 s[52:55], s[0:1], 8
    s_load_dwordx8 s[56:63], s[0:1], 32
    s_load_dwordx4 s[64:67], s[0:1], 64
    s_cmp_ge_u32 s2, 224
    s_cbranch_scc1 L_A
    v_lshrrev_b32 v22, 6, v0
    v_and_b32 v3, 63, v0
    v_readfirstlane_b32 s3, v22
    s_and_b32 s38, s2, 7
    s_lshr_b32 s39, s2, 3
    s_mul_i32 s40, s39, 37
    s_lshr_b32 s40, s40, 8
    s_mul_i32 s41, s40, 7
    s_sub_u32 s7, s39, s41
    s_lshr_b32 s4, s38, 1
    s_lshl_b32 s4, s4, 2
    s_add_u32 s4, s4, s40
    s_lshl_b32 s6, s4, 2
    s_add_u32 s6, s6, s3
    s_lshl_b32 s42, s3, 12
    s_getpc_b64 s[68:69]
L_pc:
    s_mov_b32 s70, L_codeend-L_pc
    s_mov_b32 s71, 0x20000
    s_lshl_b32 s41, s39, 11
    v_lshrrev_b32 v22, 4, v0
    v_lshlrev_b32 v23, 7, v0
    v_lshl_add_u32 v22, v22, 20, v23
    buffer_load_dword a255, v22, s[68:71], s41 offen
    s_mul_i32 s38, s40, 1
    s_mul_i32 s39, s7, 1
    s_add_u32 s38, s38, s39
    s_and_b32 s38, s38, 3
    s_mul_i32 s44, s38, 256
    v_lshrrev_b32 v22, 3, v3
    v_lshlrev_b32 v22, 6, v22
    v_add_u32 v22, s6, v22
    v_mul_u32_u24 v22, 896, v22
    v_lshrrev_b32 v23, 4, v3
    v_xor_b32 v23, v23, v3
    v_and_b32 v23, 7, v23
    v_lshl_add_u32 v4, v23, 4, v22
    v_xor_b32 v5, 64, v4
    v_add_u32 v5, 457728, v5
    v_add_u32 v6, 915456, v4
    v_add_u32 v7, 915456, v5
    s_add_u32 s45, s44, 128
    s_sub_u32 s39, s45, 896
    s_min_u32 s45, s45, s39
    s_mov_b32 s10, 1835008
    s_mov_b32 s11, 0x20000
    s_and_b32 s38, s2, 1
    s_mul_i32 s5, s38, 7
    s_add_u32 s5, s5, s7
    s_lshl_b32 s36, s4, 1
    s_add_u32 s36, s36, s38
    s_lshr_b32 s37, s4, 2
    s_and_b32 s37, s37, 3
    v_and_b32 v1, 31, v3
    v_lshrrev_b32 v2, 5, v3
    s_waitcnt lgkmcnt(0)
    s_add_u32 m0, s42, 0
    s_nop 0
    buffer_load_dwordx4 v4, s[8:11], s44 offen lds
    buffer_load_dwordx4 v5, s[8:11], s44 offen offset:1024 lds
    buffer_load_dwordx4 v6, s[8:11], s44 offen offset:2048 lds
    s_branch L_B2
L_A:
    s_cmp_ge_u32 s2, 256
    s_cbranch_scc1 L_exit
    v_lshrrev_b32 v4, 6, v0
    v_and_b32 v3, 63, v0
    v_readfirstlane_b32 s3, v4
    s_sub_u32 s4, s2, 224
    v_lshlrev_b32 v19, 4, v3
    s_lshl_b32 s38, s4, 1
    s_lshr_b32 s39, s3, 1
    s_add_u32 s38, s38, s39
    s_mul_i32 s38, s38, 14400
    s_add_u32 s14, s38, 14400
    s_mov_b32 s15, 0x20000
    s_lshl_b32 s42, s3, 14
    s_cmp_ge_u32 s4, 24
    s_cselect_b32 s40, -1, 0xffffff
    s_mul_i32 s41, s4, 34816
    v_lshrrev_b32 v5, 3, v3
    v_mul_u32_u24 v5, 4224, v5
    v_lshl_add_u32 v4, v4, 28, v19
    v_add_u32 v4, v4, v5
    v_mov_b32 v224, -1
    v_mov_b32 v225, s40
    v_mov_b32 v226, -1
    v_mov_b32 v227, s40
    s_mov_b32 s26, 268435456
    s_mov_b32 s27, 0x20000
    s_bitcmp1_b32 s3, 0
    s_waitcnt lgkmcnt(0)
    s_cselect_b64 s[12:13], s[54:55], s[52:53]
    s_mov_b64 s[24:25], s[66:67]
    buffer_store_dwordx4 v[224:227], v4, s[24:27], s41 offen sc1
    s_add_u32 m0, s42, 0
    s_nop 0
    buffer_load_dwordx4 v19, s[12:15], s38 offen offset:0 lds
    buffer_load_dwordx4 v19, s[12:15], s38 offen offset:1024 lds
    buffer_load_dwordx4 v19, s[12:15], s38 offen offset:2048 lds
    buffer_load_dwordx4 v19, s[12:15], s38 offen offset:3072 lds
    s_add_u32 m0, s42, 4096
    s_add_u32 s38, s38, 4096
    buffer_load_dwordx4 v19, s[12:15], s38 offen offset:0 lds
    buffer_load_dwordx4 v19, s[12:15], s38 offen offset:1024 lds
    buffer_load_dwordx4 v19, s[12:15], s38 offen offset:2048 lds
    buffer_load_dwordx4 v19, s[12:15], s38 offen offset:3072 lds
    s_mov_b32 s72, s3
    s_mov_b64 exec, 0
L_retA:
    s_add_u32 s72, s72, 4
    s_cmp_eq_u32 s72, 4
    s_cbranch_scc1 L_stubA0
    s_cmp_eq_u32 s72, 5
    s_cbranch_scc1 L_stubA1
    s_cmp_eq_u32 s72, 6
    s_cbranch_scc1 L_stubA2
    s_cmp_eq_u32 s72, 7
    s_cbranch_scc1 L_stubA3
    s_mov_b64 exec, -1
    s_branch L_bodyA
L_exit:
    s_endpgm
L_B2:
    s_mov_b64 s[12:13], s[56:57]
    s_mov_b64 s[16:17], s[58:59]
    s_mov_b64 s[20:21], s[60:61]
    s_mov_b64 s[28:29], s[62:63]
    s_mov_b64 s[32:33], s[64:65]
    s_mov_b64 s[24:25], s[66:67]
    s_add_u32 s46, s44, 256
    s_sub_u32 s39, s46, 896
    s_min_u32 s46, s46, s39
    s_lshl_b32 s38, s5, 4
    s_add_u32 s38, s38, 1
    v_and_b32 v240, 6, v1
    v_bfe_u32 v22, v1, 3, 1
    v_add3_u32 v240, v240, v22, s38
    v_lshrrev_b32 v22, 4, v1
    v_lshl_add_u32 v240, v22, 3, v240
    v_cvt_f32_u32 v240, v240
    s_lshl_b32 s38, s3, 4
    s_lshr_b32 s39, s44, 1
    s_add_u32 s38, s38, s39
    v_lshl_add_u32 v241, v2, 3, s38
    v_cvt_f32_u32 v241, v241
    v_mul_f32 v241, v241, v240
    v_mul_f32 v22, 0x3b124925, v241
    v_floor_f32 v22, v22
    v_fmamk_f32 v241, v22, 0xc3e00000, v241
    v_and_b32 v22, 1, v1
    v_cvt_f32_u32 v22, v22
    v_mul_f32 v22, 0x3e800000, v22
    v_fmamk_f32 v224, v241, 0x3b124925, v22
    v_mul_f32 v243, 0x3e124925, v240
    v_fract_f32 v243, v243
    v_cos_f32 v244, v243
    v_mul_f32 v240, 0x3b124925, v240
    v_add_f32 v232, v224, v243
    v_add_f32 v244, v244, v244
    s_lshl_b32 s38, s3, 10
    s_add_u32 s38, s38, 114688
    v_lshl_add_u32 v242, v3, 4, s38
    v_fmamk_f32 v225, v240, 0x3f800000, v224
    v_fmamk_f32 v226, v240, 0x40000000, v224
    v_fmamk_f32 v227, v240, 0x40400000, v224
    v_fmamk_f32 v228, v240, 0x40800000, v224
    v_fmamk_f32 v229, v240, 0x40a00000, v224
    v_fmamk_f32 v230, v240, 0x40c00000, v224
    v_fmamk_f32 v231, v240, 0x40e00000, v224
    v_cos_f32 v224, v224
    v_cos_f32 v225, v225
    v_cos_f32 v226, v226
    v_cos_f32 v227, v227
    v_cos_f32 v228, v228
    v_cos_f32 v229, v229
    v_cos_f32 v230, v230
    v_cos_f32 v231, v231
    v_cvt_pk_bf16_f32 v144, v224, v225
    v_cvt_pk_bf16_f32 v145, v226, v227
    v_cvt_pk_bf16_f32 v146, v228, v229
    v_cvt_pk_bf16_f32 v147, v230, v231
    v_fmamk_f32 v233, v240, 0x3f800000, v232
    v_fmamk_f32 v234, v240, 0x40000000, v232
    v_fmamk_f32 v235, v240, 0x40400000, v232
    v_fmamk_f32 v236, v240, 0x40800000, v232
    v_fmamk_f32 v237, v240, 0x40a00000, v232
    v_fmamk_f32 v238, v240, 0x40c00000, v232
    v_fmamk_f32 v239, v240, 0x40e00000, v232
    v_cos_f32 v232, v232
    v_cos_f32 v233, v233
    v_cos_f32 v234, v234
    v_cos_f32 v235, v235
    v_cos_f32 v236, v236
    v_cos_f32 v237, v237
    v_cos_f32 v238, v238
    v_cos_f32 v239, v239
    v_cvt_pk_bf16_f32 v148, v232, v233
    v_cvt_pk_bf16_f32 v149, v234, v235
    v_cvt_pk_bf16_f32 v150, v236, v237
    v_cvt_pk_bf16_f32 v151, v238, v239
    buffer_load_dwordx4 v7, s[8:11], s44 offen offset:3072 lds
    s_add_u32 m0, s42, 16384
    s_nop 0
    buffer_load_dwordx4 v4, s[8:11], s45 offen lds
    buffer_load_dwordx4 v5, s[8:11], s45 offen offset:1024 lds
    buffer_load_dwordx4 v6, s[8:11], s45 offen offset:2048 lds
    buffer_load_dwordx4 v7, s[8:11], s45 offen offset:3072 lds
    s_add_u32 m0, s42, 32768
    s_nop 0
    buffer_load_dwordx4 v4, s[8:11], s46 offen lds
    buffer_load_dwordx4 v5, s[8:11], s46 offen offset:1024 lds
    v_pk_fma_f32 v[224:225], v[232:233], v[244:245], v[224:225] op_sel_hi:[1,0,1] neg_lo:[0,0,1] neg_hi:[0,0,1]
    v_pk_fma_f32 v[226:227], v[234:235], v[244:245], v[226:227] op_sel_hi:[1,0,1] neg_lo:[0,0,1] neg_hi:[0,0,1]
    v_pk_fma_f32 v[228:229], v[236:237], v[244:245], v[228:229] op_sel_hi:[1,0,1] neg_lo:[0,0,1] neg_hi:[0,0,1]
    v_pk_fma_f32 v[230:231], v[238:239], v[244:245], v[230:231] op_sel_hi:[1,0,1] neg_lo:[0,0,1] neg_hi:[0,0,1]
    v_cvt_pk_bf16_f32 v152, v224, v225
    v_cvt_pk_bf16_f32 v153, v226, v227
    v_cvt_pk_bf16_f32 v154, v228, v229
    v_cvt_pk_bf16_f32 v155, v230, v231
    ds_write_b128 v242, v[144:147] offset:0
    ds_write_b128 v242, v[148:151] offset:4096
    v_pk_fma_f32 v[232:233], v[224:225], v[244:245], v[232:233] op_sel_hi:[1,0,1] neg_lo:[0,0,1] neg_hi:[0,0,1]
    v_pk_fma_f32 v[234:235], v[226:227], v[244:245], v[234:235] op_sel_hi:[1,0,1] neg_lo:[0,0,1] neg_hi:[0,0,1]
    v_pk_fma_f32 v[236:237], v[228:229], v[244:245], v[236:237] op_sel_hi:[1,0,1] neg_lo:[0,0,1] neg_hi:[0,0,1]
    v_pk_fma_f32 v[238:239], v[230:231], v[244:245], v[238:239] op_sel_hi:[1,0,1] neg_lo:[0,0,1] neg_hi:[0,0,1]
    v_cvt_pk_bf16_f32 v156, v232, v233
    v_cvt_pk_bf16_f32 v157, v234, v235
    v_cvt_pk_bf16_f32 v158, v236, v237
    v_cvt_pk_bf16_f32 v159, v238, v239
    v_pk_fma_f32 v[224:225], v[232:233], v[244:245], v[224:225] op_sel_hi:[1,0,1] neg_lo:[0,0,1] neg_hi:[0,0,1]
    v_pk_fma_f32 v[226:227], v[234:235], v[244:245], v[226:227] op_sel_hi:[1,0,1] neg_lo:[0,0,1] neg_hi:[0,0,1]
    v_pk_fma_f32 v[228:229], v[236:237], v[244:245], v[228:229] op_sel_hi:[1,0,1] neg_lo:[0,0,1] neg_hi:[0,0,1]
    v_pk_fma_f32 v[230:231], v[238:239], v[244:245], v[230:231] op_sel_hi:[1,0,1] neg_lo:[0,0,1] neg_hi:[0,0,1]
    v_cvt_pk_bf16_f32 v160, v224, v225
    v_cvt_pk_bf16_f32 v161, v226, v227
    v_cvt_pk_bf16_f32 v162, v228, v229
    v_cvt_pk_bf16_f32 v163, v230, v231
    ds_write_b128 v242, v[152:155] offset:8192
    ds_write_b128 v242, v[156:159] offset:12288
    v_pk_fma_f32 v[232:233], v[224:225], v[244:245], v[232:233] op_sel_hi:[1,0,1] neg_lo:[0,0,1] neg_hi:[0,0,1]
    v_pk_fma_f32 v[234:235], v[226:227], v[244:245], v[234:235] op_sel_hi:[1,0,1] neg_lo:[0,0,1] neg_hi:[0,0,1]
    v_pk_fma_f32 v[236:237], v[228:229], v[244:245], v[236:237] op_sel_hi:[1,0,1] neg_lo:[0,0,1] neg_hi:[0,0,1]
    v_pk_fma_f32 v[238:239], v[230:231], v[244:245], v[238:239] op_sel_hi:[1,0,1] neg_lo:[0,0,1] neg_hi:[0,0,1]
    v_cvt_pk_bf16_f32 v164, v232, v233
    v_cvt_pk_bf16_f32 v165, v234, v235
    v_cvt_pk_bf16_f32 v166, v236, v237
    v_cvt_pk_bf16_f32 v167, v238, v239
    v_pk_fma_f32 v[224:225], v[232:233], v[244:245], v[224:225] op_sel_hi:[1,0,1] neg_lo:[0,0,1] neg_hi:[0,0,1]
    v_pk_fma_f32 v[226:227], v[234:235], v[244:245], v[226:227] op_sel_hi:[1,0,1] neg_lo:[0,0,1] neg_hi:[0,0,1]
    v_pk_fma_f32 v[228:229], v[236:237], v[244:245], v[228:229] op_sel_hi:[1,0,1] neg_lo:[0,0,1] neg_hi:[0,0,1]
    v_pk_fma_f32 v[230:231], v[238:239], v[244:245], v[230:231] op_sel_hi:[1,0,1] neg_lo:[0,0,1] neg_hi:[0,0,1]
    v_cvt_pk_bf16_f32 v168, v224, v225
    v_cvt_pk_bf16_f32 v169, v226, v227
    v_cvt_pk_bf16_f32 v170, v228, v229
    v_cvt_pk_bf16_f32 v171, v230, v231
    ds_write_b128 v242, v[160:163] offset:16384
    ds_write_b128 v242, v[164:167] offset:20480
    ds_write_b128 v242, v[168:171] offset:24576
    s_add_u32 s47, s44, 384
    s_sub_u32 s39, s47, 896
    s_min_u32 s47, s47, s39
    s_add_u32 s48, s44, 512
    s_sub_u32 s39, s48, 896
    s_min_u32 s48, s48, s39
    s_add_u32 s49, s44, 640
    s_sub_u32 s39, s49, 896
    s_min_u32 s49, s49, s39
    s_add_u32 s50, s44, 768
    s_sub_u32 s39, s50, 896
    s_min_u32 s50, s50, s39
    s_mov_b32 s14, 1605632
    s_mov_b32 s15, 0x20000
    s_mov_b32 s18, 1605632
    s_mov_b32 s19, 0x20000
    v_lshrrev_b32 v22, 1, v1
    v_xor_b32 v22, v22, v2
    v_and_b32 v22, 7, v22
    v_lshl_add_u32 v23, v1, 7, s42
    v_lshl_add_u32 v8, v22, 4, v23
    v_xor_b32 v9, 32, v8
    v_xor_b32 v10, 64, v8
    v_xor_b32 v11, 96, v8
    v_lshlrev_b32 v20, 4, v3
    v_add_u32 v20, 114688, v20
    v_mov_b32 v18, 0
    v_mov_b32 v19, 0
    v_mov_b32 v21, 0x3f803f80
    s_mul_i32 s38, s3, 57344
    s_lshl_b32 s39, s5, 8
    s_add_u32 s38, s38, s39
    s_lshr_b32 s39, s37, 1
    s_lshl_b32 s39, s39, 7
    s_add_u32 s38, s38, s39
    v_lshrrev_b32 v22, 2, v3
    v_and_b32 v22, 4, v22
    v_xor_b32 v22, v22, v3
    v_and_b32 v22, 7, v22
    v_lshlrev_b32 v22, 4, v22
    v_lshrrev_b32 v23, 3, v3
    v_mul_u32_u24 v12, 3584, v23
    v_add3_u32 v12, v12, v22, s38
    v_add_u32 v13, 27648, v12
    s_mul_i32 s51, s44, 1792
    s_mul_i32 s52, s45, 1792
    s_mul_i32 s53, s46, 1792
    s_mul_i32 s54, s47, 1792
    s_mul_i32 s55, s48, 1792
    s_mul_i32 s56, s49, 1792
    s_mul_i32 s57, s50, 1792
    s_mov_b32 s26, 268435456
    s_mov_b32 s27, 0x20000
    s_mov_b32 s34, 256
    s_mov_b32 s35, 0x20000
    s_waitcnt lgkmcnt(0)
    s_barrier
    ds_read_b128 a[0:3], v20 offset:0
    ds_read_b128 a[4:7], v20 offset:1024
    ds_read_b128 a[8:11], v20 offset:2048
    ds_read_b128 a[12:15], v20 offset:3072
    v_and_b32 v22, 1, v1
    v_lshlrev_b32 v22, 4, v22
    v_mov_b32 v23, 0x3f80
    v_lshlrev_b32 v22, v22, v23
    v_lshrrev_b32 v23, 1, v1
    v_lshlrev_b32 v24, 2, v2
    v_sub_u32 v23, v23, v24
    v_cmp_eq_u32 s[58:59], 0, v23
    v_cmp_eq_u32 s[60:61], 1, v23
    v_cmp_eq_u32 s[62:63], 2, v23
    v_cmp_eq_u32 vcc, 3, v23
    v_cndmask_b32 v24, 0, v22, s[58:59]
    v_cndmask_b32 v25, 0, v22, s[60:61]
    v_cndmask_b32 v26, 0, v22, s[62:63]
    v_cndmask_b32 v27, 0, v22, vcc
    v_cmp_eq_u32 s[58:59], 8, v23
    v_cmp_eq_u32 s[60:61], 9, v23
    v_cmp_eq_u32 s[62:63], 10, v23
    v_cmp_eq_u32 vcc, 11, v23
    v_cndmask_b32 v28, 0, v22, s[58:59]
    v_cndmask_b32 v29, 0, v22, s[60:61]
    v_cndmask_b32 v30, 0, v22, s[62:63]
    v_cndmask_b32 v31, 0, v22, vcc
    v_bfe_u32 v22, v3, 2, 2
    v_lshl_add_u32 v22, v2, 2, v22
    v_lshlrev_b32 v14, 7, v22
    v_bfe_u32 v22, v3, 3, 1
    v_lshl_add_u32 v14, v22, 6, v14
    v_bfe_u32 v22, v3, 4, 1
    v_lshl_add_u32 v14, v22, 5, v14
    v_and_b32 v22, 3, v3
    v_lshl_add_u32 v14, v22, 3, v14
    s_and_b32 s73, s37, 1
    s_lshl_b32 s73, s73, 6
    v_xor_b32 v14, s73, v14
    v_xor_b32 v15, 64, v14
    v_add_u32 v16, 0x10000, v14
    v_add_u32 v17, 0x10000, v15
    s_waitcnt vmcnt(6)
    ds_read_b128 v[32:35], v8 offset:0
    ds_read_b128 v[36:39], v9 offset:0
    ds_read_b128 v[40:43], v10 offset:0
    ds_read_b128 v[44:47], v11 offset:0
    s_branch L_bodyB
.p2align 12
L_bodyB:
    s_waitcnt lgkmcnt(3)
    v_mfma_f32_32x32x16_bf16 v[224:239], v[32:35], a[0:3], 0
    ds_read_b128 a[16:19], v20 offset:4096
    buffer_load_dwordx4 v6, s[8:11], s46 offen offset:2048 lds
    v_cvt_f32_u32 v240, v1
    v_lshl_add_u32 v241, v2, 8, s6
    v_cvt_f32_u32 v241, v241
    s_waitcnt lgkmcnt(3)
    v_mfma_f32_32x32x16_bf16 v[224:239], v[36:39], a[4:7], v[224:239]
    ds_read_b128 a[20:23], v20 offset:5120
    buffer_load_dwordx4 v7, s[8:11], s46 offen offset:3072 lds
    v_mul_f32 v240, 0x3d000000, v240
    v_mul_f32 v241, 0x3c800000, v241
    v_mul_f32 v241, v241, v240
    s_waitcnt lgkmcnt(3)
    v_mfma_f32_32x32x16_bf16 v[224:239], v[40:43], a[8:11], v[224:239]
    s_add_u32 m0, s42, 49152
    ds_read_b128 a[24:27], v20 offset:6144
    buffer_load_dwordx4 v4, s[8:11], s47 offen lds
    v_lshlrev_b32 v0, 31, v1
    v_lshrrev_b32 v22, 16, v0
    v_or_b32 v0, v0, v22
    s_waitcnt lgkmcnt(3)
    v_mfma_f32_32x32x16_bf16 v[224:239], v[44:47], a[12:15], v[224:239]
    ds_read_b128 a[28:31], v20 offset:7168
    buffer_load_dwordx4 v5, s[8:11], s47 offen offset:1024 lds
    s_waitcnt vmcnt(6)
    ds_read_b128 v[48:51], v8 offset:16384
    ds_read_b128 v[52:55], v9 offset:16384
    ds_read_b128 v[56:59], v10 offset:16384
    ds_read_b128 v[60:63], v11 offset:16384
    v_dot2c_f32_bf16 v18, v32, v21
    v_dot2c_f32_bf16 v19, v32, v32
    v_dot2c_f32_bf16 v18, v33, v21
    v_dot2c_f32_bf16 v19, v33, v33
    v_dot2c_f32_bf16 v18, v34, v21
    v_dot2c_f32_bf16 v19, v34, v34
    v_dot2c_f32_bf16 v18, v35, v21
    v_dot2c_f32_bf16 v19, v35, v35
    v_dot2c_f32_bf16 v18, v36, v21
    v_dot2c_f32_bf16 v19, v36, v36
    v_dot2c_f32_bf16 v18, v37, v21
    v_dot2c_f32_bf16 v19, v37, v37
    v_dot2c_f32_bf16 v18, v38, v21
    v_dot2c_f32_bf16 v19, v38, v38
    v_dot2c_f32_bf16 v18, v39, v21
    v_dot2c_f32_bf16 v19, v39, v39
    v_dot2c_f32_bf16 v18, v40, v21
    v_dot2c_f32_bf16 v19, v40, v40
    v_dot2c_f32_bf16 v18, v41, v21
    v_dot2c_f32_bf16 v19, v41, v41
    v_dot2c_f32_bf16 v18, v42, v21
    v_dot2c_f32_bf16 v19, v42, v42
    v_dot2c_f32_bf16 v18, v43, v21
    v_dot2c_f32_bf16 v19, v43, v43
    v_dot2c_f32_bf16 v18, v44, v21
    v_dot2c_f32_bf16 v19, v44, v44
    v_dot2c_f32_bf16 v18, v45, v21
    v_dot2c_f32_bf16 v19, v45, v45
    v_dot2c_f32_bf16 v18, v46, v21
    v_dot2c_f32_bf16 v19, v46, v46
    v_dot2c_f32_bf16 v18, v47, v21
    v_dot2c_f32_bf16 v19, v47, v47
    s_waitcnt lgkmcnt(3)
    v_mfma_f32_32x32x16_bf16 v[224:239], v[48:51], a[16:19], v[224:239]
    ds_read_b128 a[0:3], v20 offset:8192
    buffer_load_dwordx4 v6, s[8:11], s47 offen offset:2048 lds
    v_fmamk_f32 v242, v240, 0x00000000, v241
    v_fmamk_f32 v243, v240, 0x3f800000, v241
    v_fmamk_f32 v246, v240, 0x40000000, v241
    s_waitcnt lgkmcnt(3)
    v_mfma_f32_32x32x16_bf16 v[224:239], v[52:55], a[20:23], v[224:239]
    ds_read_b128 a[4:7], v20 offset:9216
    buffer_load_dwordx4 v7, s[8:11], s47 offen offset:3072 lds
    v_cos_f32 v244, v242
    v_fmamk_f32 v247, v240, 0x40400000, v241
    s_waitcnt lgkmcnt(3)
    v_mfma_f32_32x32x16_bf16 v[224:239], v[56:59], a[24:27], v[224:239]
    s_add_u32 m0, s42, 65536
    ds_read_b128 a[8:11], v20 offset:10240
    buffer_load_dwordx4 v4, s[8:11], s48 offen lds
    v_cos_f32 v245, v243
    s_waitcnt lgkmcnt(3)
    v_mfma_f32_32x32x16_bf16 v[224:239], v[60:63], a[28:31], v[224:239]
    ds_read_b128 a[12:15], v20 offset:11264
    buffer_load_dwordx4 v5, s[8:11], s48 offen offset:1024 lds
    s_waitcnt vmcnt(6)
    ds_read_b128 v[64:67], v8 offset:32768
    ds_read_b128 v[68:71], v9 offset:32768
    ds_read_b128 v[72:75], v10 offset:32768
    ds_read_b128 v[76:79], v11 offset:32768
    v_dot2c_f32_bf16 v18, v48, v21
    v_dot2c_f32_bf16 v19, v48, v48
    v_dot2c_f32_bf16 v18, v49, v21
    v_dot2c_f32_bf16 v19, v49, v49
    v_dot2c_f32_bf16 v18, v50, v21
    v_dot2c_f32_bf16 v19, v50, v50
    v_dot2c_f32_bf16 v18, v51, v21
    v_dot2c_f32_bf16 v19, v51, v51
    v_dot2c_f32_bf16 v18, v52, v21
    v_dot2c_f32_bf16 v19, v52, v52
    v_dot2c_f32_bf16 v18, v53, v21
    v_dot2c_f32_bf16 v19, v53, v53
    v_dot2c_f32_bf16 v18, v54, v21
    v_dot2c_f32_bf16 v19, v54, v54
    v_dot2c_f32_bf16 v18, v55, v21
    v_dot2c_f32_bf16 v19, v55, v55
    v_dot2c_f32_bf16 v18, v56, v21
    v_dot2c_f32_bf16 v19, v56, v56
    v_dot2c_f32_bf16 v18, v57, v21
    v_dot2c_f32_bf16 v19, v57, v57
    v_dot2c_f32_bf16 v18, v58, v21
    v_dot2c_f32_bf16 v19, v58, v58
    v_dot2c_f32_bf16 v18, v59, v21
    v_dot2c_f32_bf16 v19, v59, v59
    v_dot2c_f32_bf16 v18, v60, v21
    v_dot2c_f32_bf16 v19, v60, v60
    v_dot2c_f32_bf16 v18, v61, v21
    v_dot2c_f32_bf16 v19, v61, v61
    v_dot2c_f32_bf16 v18, v62, v21
    v_dot2c_f32_bf16 v19, v62, v62
    v_dot2c_f32_bf16 v18, v63, v21
    v_dot2c_f32_bf16 v19, v63, v63
    s_waitcnt lgkmcnt(3)
    v_mfma_f32_32x32x16_bf16 v[224:239], v[64:67], a[0:3], v[224:239]
    ds_read_b128 a[16:19], v20 offset:12288
    buffer_load_dwordx4 v6, s[8:11], s48 offen offset:2048 lds
    v_sin_f32 v242, v242
    v_cvt_pk_bf16_f32 v208, v244, v245
    s_waitcnt lgkmcnt(3)
    v_mfma_f32_32x32x16_bf16 v[224:239], v[68:71], a[4:7], v[224:239]
    ds_read_b128 a[20:23], v20 offset:13312
    buffer_load_dwordx4 v7, s[8:11], s48 offen offset:3072 lds
    v_sin_f32 v243, v243
    s_waitcnt lgkmcnt(3)
    v_mfma_f32_32x32x16_bf16 v[224:239], v[72:75], a[8:11], v[224:239]
    s_add_u32 m0, s42, 81920
    ds_read_b128 a[24:27], v20 offset:14336
    buffer_load_dwordx4 v4, s[8:11], s49 offen lds
    v_cvt_pk_bf16_f32 v216, v242, v243
    v_cos_f32 v248, v246
    s_waitcnt lgkmcnt(3)
    v_mfma_f32_32x32x16_bf16 v[224:239], v[76:79], a[12:15], v[224:239]
    ds_read_b128 a[28:31], v20 offset:15360
    buffer_load_dwordx4 v5, s[8:11], s49 offen offset:1024 lds
    s_waitcnt vmcnt(6)
    ds_read_b128 v[80:83], v8 offset:49152
    ds_read_b128 v[84:87], v9 offset:49152
    ds_read_b128 v[88:91], v10 offset:49152
    ds_read_b128 v[92:95], v11 offset:49152
    v_dot2c_f32_bf16 v18, v64, v21
    v_dot2c_f32_bf16 v19, v64, v64
    v_dot2c_f32_bf16 v18, v65, v21
    v_dot2c_f32_bf16 v19, v65, v65
    v_dot2c_f32_bf16 v18, v66, v21
    v_dot2c_f32_bf16 v19, v66, v66
    v_dot2c_f32_bf16 v18, v67, v21
    v_dot2c_f32_bf16 v19, v67, v67
    v_dot2c_f32_bf16 v18, v68, v21
    v_dot2c_f32_bf16 v19, v68, v68
    v_dot2c_f32_bf16 v18, v69, v21
    v_dot2c_f32_bf16 v19, v69, v69
    v_dot2c_f32_bf16 v18, v70, v21
    v_dot2c_f32_bf16 v19, v70, v70
    v_dot2c_f32_bf16 v18, v71, v21
    v_dot2c_f32_bf16 v19, v71, v71
    v_dot2c_f32_bf16 v18, v72, v21
    v_dot2c_f32_bf16 v19, v72, v72
    v_dot2c_f32_bf16 v18, v73, v21
    v_dot2c_f32_bf16 v19, v73, v73
    v_dot2c_f32_bf16 v18, v74, v21
    v_dot2c_f32_bf16 v19, v74, v74
    v_dot2c_f32_bf16 v18, v75, v21
    v_dot2c_f32_bf16 v19, v75, v75
    v_dot2c_f32_bf16 v18, v76, v21
    v_dot2c_f32_bf16 v19, v76, v76
    v_dot2c_f32_bf16 v18, v77, v21
    v_dot2c_f32_bf16 v19, v77, v77
    v_dot2c_f32_bf16 v18, v78, v21
    v_dot2c_f32_bf16 v19, v78, v78
    v_dot2c_f32_bf16 v18, v79, v21
    v_dot2c_f32_bf16 v19, v79, v79
    s_waitcnt lgkmcnt(3)
    v_mfma_f32_32x32x16_bf16 v[224:239], v[80:83], a[16:19], v[224:239]
    ds_read_b128 a[0:3], v20 offset:16384
    buffer_load_dwordx4 v6, s[8:11], s49 offen offset:2048 lds
    v_cos_f32 v249, v247
    v_fmamk_f32 v242, v240, 0x41000000, v241
    s_waitcnt lgkmcnt(3)
    v_mfma_f32_32x32x16_bf16 v[224:239], v[84:87], a[20:23], v[224:239]
    ds_read_b128 a[4:7], v20 offset:17408
    buffer_load_dwordx4 v7, s[8:11], s49 offen offset:3072 lds
    v_sin_f32 v246, v246
    v_cvt_pk_bf16_f32 v209, v248, v249
    s_waitcnt lgkmcnt(3)
    v_mfma_f32_32x32x16_bf16 v[224:239], v[88:91], a[24:27], v[224:239]
    s_add_u32 m0, s42, 98304
    ds_read_b128 a[8:11], v20 offset:18432
    buffer_load_dwordx4 v4, s[8:11], s50 offen lds
    v_add_u32 v8, 0x10000, v8
    v_add_u32 v9, 0x10000, v9
    v_add_u32 v10, 0x10000, v10
    v_add_u32 v11, 0x10000, v11
    s_waitcnt lgkmcnt(3)
    v_mfma_f32_32x32x16_bf16 v[224:239], v[92:95], a[28:31], v[224:239]
    ds_read_b128 a[12:15], v20 offset:19456
    buffer_load_dwordx4 v5, s[8:11], s50 offen offset:1024 lds
    s_waitcnt vmcnt(6)
    ds_read_b128 v[96:99], v8 offset:0
    ds_read_b128 v[100:103], v9 offset:0
    ds_read_b128 v[104:107], v10 offset:0
    ds_read_b128 v[108:111], v11 offset:0
    v_dot2c_f32_bf16 v18, v80, v21
    v_dot2c_f32_bf16 v19, v80, v80
    v_dot2c_f32_bf16 v18, v81, v21
    v_dot2c_f32_bf16 v19, v81, v81
    v_dot2c_f32_bf16 v18, v82, v21
    v_dot2c_f32_bf16 v19, v82, v82
    v_dot2c_f32_bf16 v18, v83, v21
    v_dot2c_f32_bf16 v19, v83, v83
    v_dot2c_f32_bf16 v18, v84, v21
    v_dot2c_f32_bf16 v19, v84, v84
    v_dot2c_f32_bf16 v18, v85, v21
    v_dot2c_f32_bf16 v19, v85, v85
    v_dot2c_f32_bf16 v18, v86, v21
    v_dot2c_f32_bf16 v19, v86, v86
    v_dot2c_f32_bf16 v18, v87, v21
    v_dot2c_f32_bf16 v19, v87, v87
    v_dot2c_f32_bf16 v18, v88, v21
    v_dot2c_f32_bf16 v19, v88, v88
    v_dot2c_f32_bf16 v18, v89, v21
    v_dot2c_f32_bf16 v19, v89, v89
    v_dot2c_f32_bf16 v18, v90, v21
    v_dot2c_f32_bf16 v19, v90, v90
    v_dot2c_f32_bf16 v18, v91, v21
    v_dot2c_f32_bf16 v19, v91, v91
    v_dot2c_f32_bf16 v18, v92, v21
    v_dot2c_f32_bf16 v19, v92, v92
    v_dot2c_f32_bf16 v18, v93, v21
    v_dot2c_f32_bf16 v19, v93, v93
    v_dot2c_f32_bf16 v18, v94, v21
    v_dot2c_f32_bf16 v19, v94, v94
    v_dot2c_f32_bf16 v18, v95, v21
    v_dot2c_f32_bf16 v19, v95, v95
    s_waitcnt lgkmcnt(3)
    v_mfma_f32_32x32x16_bf16 v[224:239], v[96:99], a[0:3], v[224:239]
    ds_read_b128 a[16:19], v20 offset:20480
    buffer_load_dwordx4 v6, s[8:11], s50 offen offset:2048 lds
    v_sin_f32 v247, v247
    v_fmamk_f32 v243, v240, 0x41100000, v241
    s_waitcnt lgkmcnt(3)
    v_mfma_f32_32x32x16_bf16 v[224:239], v[100:103], a[4:7], v[224:239]
    ds_read_b128 a[20:23], v20 offset:21504
    buffer_load_dwordx4 v7, s[8:11], s50 offen offset:3072 lds
    v_cvt_pk_bf16_f32 v217, v246, v247
    v_cos_f32 v244, v242
    s_waitcnt lgkmcnt(3)
    v_mfma_f32_32x32x16_bf16 v[224:239], v[104:107], a[8:11], v[224:239]
    s_barrier
    s_add_u32 m0, s42, 0
    ds_read_b128 a[24:27], v20 offset:22528
    buffer_load_dwordx4 v12, s[12:15], s51 offen lds
    v_cos_f32 v245, v243
    s_waitcnt lgkmcnt(3)
    v_mfma_f32_32x32x16_bf16 v[224:239], v[108:111], a[12:15], v[224:239]
    ds_read_b128 a[28:31], v20 offset:23552
    buffer_load_dwordx4 v13, s[12:15], s51 offen offset:1024 lds
    s_waitcnt vmcnt(6)
    ds_read_b128 v[112:115], v8 offset:16384
    ds_read_b128 v[116:119], v9 offset:16384
    ds_read_b128 v[120:123], v10 offset:16384
    ds_read_b128 v[124:127], v11 offset:16384
    v_dot2c_f32_bf16 v18, v96, v21
    v_dot2c_f32_bf16 v19, v96, v96
    v_dot2c_f32_bf16 v18, v97, v21
    v_dot2c_f32_bf16 v19, v97, v97
    v_dot2c_f32_bf16 v18, v98, v21
    v_dot2c_f32_bf16 v19, v98, v98
    v_dot2c_f32_bf16 v18, v99, v21
    v_dot2c_f32_bf16 v19, v99, v99
    v_dot2c_f32_bf16 v18, v100, v21
    v_dot2c_f32_bf16 v19, v100, v100
    v_dot2c_f32_bf16 v18, v101, v21
    v_dot2c_f32_bf16 v19, v101, v101
    v_dot2c_f32_bf16 v18, v102, v21
    v_dot2c_f32_bf16 v19, v102, v102
    v_dot2c_f32_bf16 v18, v103, v21
    v_dot2c_f32_bf16 v19, v103, v103
    v_dot2c_f32_bf16 v18, v104, v21
    v_dot2c_f32_bf16 v19, v104, v104
    v_dot2c_f32_bf16 v18, v105, v21
    v_dot2c_f32_bf16 v19, v105, v105
    v_dot2c_f32_bf16 v18, v106, v21
    v_dot2c_f32_bf16 v19, v106, v106
    v_dot2c_f32_bf16 v18, v107, v21
    v_dot2c_f32_bf16 v19, v107, v107
    v_dot2c_f32_bf16 v18, v108, v21
    v_dot2c_f32_bf16 v19, v108, v108
    v_dot2c_f32_bf16 v18, v109, v21
    v_dot2c_f32_bf16 v19, v109, v109
    v_dot2c_f32_bf16 v18, v110, v21
    v_dot2c_f32_bf16 v19, v110, v110
    v_dot2c_f32_bf16 v18, v111, v21
    v_dot2c_f32_bf16 v19, v111, v111
    s_waitcnt lgkmcnt(3)
    v_mfma_f32_32x32x16_bf16 v[224:239], v[112:115], a[16:19], v[224:239]
    s_add_u32 m0, s42, 16384
    ds_read_b128 a[0:3], v20 offset:24576
    buffer_load_dwordx4 v12, s[12:15], s52 offen lds
    v_sin_f32 v242, v242
    v_cvt_pk_bf16_f32 v210, v244, v245
    s_waitcnt lgkmcnt(3)
    v_mfma_f32_32x32x16_bf16 v[224:239], v[116:119], a[20:23], v[224:239]
    ds_read_b128 a[4:7], v20 offset:25600
    buffer_load_dwordx4 v13, s[12:15], s52 offen offset:1024 lds
    v_sin_f32 v243, v243
    v_fmamk_f32 v246, v240, 0x41200000, v241
    s_waitcnt lgkmcnt(3)
    v_mfma_f32_32x32x16_bf16 v[224:239], v[120:123], a[24:27], v[224:239]
    s_add_u32 m0, s42, 2048
    ds_read_b128 a[8:11], v20 offset:26624
    buffer_load_dwordx4 v12, s[16:19], s51 offen lds
    v_cvt_pk_bf16_f32 v218, v242, v243
    v_fmamk_f32 v247, v240, 0x41300000, v241
    v_xor_b32 v212, v0, v208
    s_waitcnt lgkmcnt(3)
    v_mfma_f32_32x32x16_bf16 v[224:239], v[124:127], a[28:31], v[224:239]
    ds_read_b128 a[12:15], v20 offset:27648
    buffer_load_dwordx4 v13, s[16:19], s51 offen offset:1024 lds
    s_waitcnt vmcnt(6)
    ds_read_b128 v[128:131], v8 offset:32768
    ds_read_b128 v[132:135], v9 offset:32768
    ds_read_b128 v[136:139], v10 offset:32768
    ds_read_b128 v[140:143], v11 offset:32768
    v_dot2c_f32_bf16 v18, v112, v21
    v_dot2c_f32_bf16 v19, v112, v112
    v_dot2c_f32_bf16 v18, v113, v21
    v_dot2c_f32_bf16 v19, v113, v113
    v_dot2c_f32_bf16 v18, v114, v21
    v_dot2c_f32_bf16 v19, v114, v114
    v_dot2c_f32_bf16 v18, v115, v21
    v_dot2c_f32_bf16 v19, v115, v115
    v_dot2c_f32_bf16 v18, v116, v21
    v_dot2c_f32_bf16 v19, v116, v116
    v_dot2c_f32_bf16 v18, v117, v21
    v_dot2c_f32_bf16 v19, v117, v117
    v_dot2c_f32_bf16 v18, v118, v21
    v_dot2c_f32_bf16 v19, v118, v118
    v_dot2c_f32_bf16 v18, v119, v21
    v_dot2c_f32_bf16 v19, v119, v119
    v_dot2c_f32_bf16 v18, v120, v21
    v_dot2c_f32_bf16 v19, v120, v120
    v_dot2c_f32_bf16 v18, v121, v21
    v_dot2c_f32_bf16 v19, v121, v121
    v_dot2c_f32_bf16 v18, v122, v21
    v_dot2c_f32_bf16 v19, v122, v122
    v_dot2c_f32_bf16 v18, v123, v21
    v_dot2c_f32_bf16 v19, v123, v123
    v_dot2c_f32_bf16 v18, v124, v21
    v_dot2c_f32_bf16 v19, v124, v124
    v_dot2c_f32_bf16 v18, v125, v21
    v_dot2c_f32_bf16 v19, v125, v125
    v_dot2c_f32_bf16 v18, v126, v21
    v_dot2c_f32_bf16 v19, v126, v126
    v_dot2c_f32_bf16 v18, v127, v21
    v_dot2c_f32_bf16 v19, v127, v127
    s_waitcnt lgkmcnt(3)
    v_mfma_f32_32x32x16_bf16 v[224:239], v[128:131], a[0:3], v[224:239]
    s_add_u32 m0, s42, 18432
    s_nop 0
    buffer_load_dwordx4 v12, s[16:19], s52 offen lds
    v_cos_f32 v248, v246
    v_cos_f32 v249, v247
    s_waitcnt lgkmcnt(2)
    v_mfma_f32_32x32x16_bf16 v[224:239], v[132:135], a[4:7], v[224:239]
    buffer_load_dwordx4 v13, s[16:19], s52 offen offset:1024 lds
    v_sin_f32 v246, v246
    v_sin_f32 v247, v247
    v_cvt_pk_bf16_f32 v211, v248, v249
    s_waitcnt lgkmcnt(1)
    v_mfma_f32_32x32x16_bf16 v[224:239], v[136:139], a[8:11], v[224:239]
    v_cvt_pk_bf16_f32 v219, v246, v247
    v_xor_b32 v213, v0, v209
    v_xor_b32 v214, v0, v210
    v_xor_b32 v215, v0, v211
    v_xor_b32 v220, v0, v216
    v_xor_b32 v221, v0, v217
    v_xor_b32 v222, v0, v218
    s_waitcnt lgkmcnt(0)
    v_mfma_f32_32x32x16_bf16 v[224:239], v[140:143], a[12:15], v[224:239]
    v_xor_b32 v223, v0, v219
    s_lshl_b32 s38, s3, 7
    s_add_u32 s38, s38, 143360
    v_lshl_add_u32 v6, v1, 2, s38
    v_lshl_add_u32 v7, v2, 4, s38
    s_lshl_b32 s38, s3, 1
    v_xor_b32 v4, s38, v1
    v_and_b32 v4, 7, v4
    v_lshlrev_b32 v4, 4, v4
    v_lshl_add_u32 v4, v2, 7, v4
    v_lshrrev_b32 v22, 3, v1
    v_lshl_add_u32 v4, v22, 15, v4
    s_lshl_b32 s71, s5, 17
    s_lshl_b32 s39, s6, 9
    s_add_u32 s71, s71, s39
    s_add_u32 s71, s71, 2097152
    v_xor_b32 v5, 16, v4
    v_dot2c_f32_bf16 v18, v128, v21
    v_dot2c_f32_bf16 v19, v128, v128
    v_dot2c_f32_bf16 v18, v129, v21
    v_dot2c_f32_bf16 v19, v129, v129
    v_dot2c_f32_bf16 v18, v130, v21
    v_dot2c_f32_bf16 v19, v130, v130
    v_dot2c_f32_bf16 v18, v131, v21
    v_dot2c_f32_bf16 v19, v131, v131
    v_dot2c_f32_bf16 v18, v132, v21
    v_dot2c_f32_bf16 v19, v132, v132
    v_dot2c_f32_bf16 v18, v133, v21
    v_dot2c_f32_bf16 v19, v133, v133
    v_dot2c_f32_bf16 v18, v134, v21
    v_dot2c_f32_bf16 v19, v134, v134
    v_dot2c_f32_bf16 v18, v135, v21
    v_dot2c_f32_bf16 v19, v135, v135
    v_dot2c_f32_bf16 v18, v136, v21
    v_dot2c_f32_bf16 v19, v136, v136
    v_dot2c_f32_bf16 v18, v137, v21
    v_dot2c_f32_bf16 v19, v137, v137
    v_dot2c_f32_bf16 v18, v138, v21
    v_dot2c_f32_bf16 v19, v138, v138
    v_dot2c_f32_bf16 v18, v139, v21
    v_dot2c_f32_bf16 v19, v139, v139
    v_dot2c_f32_bf16 v18, v140, v21
    v_dot2c_f32_bf16 v19, v140, v140
    v_dot2c_f32_bf16 v18, v141, v21
    v_dot2c_f32_bf16 v19, v141, v141
    v_dot2c_f32_bf16 v18, v142, v21
    v_dot2c_f32_bf16 v19, v142, v142
    v_dot2c_f32_bf16 v18, v143, v21
    v_dot2c_f32_bf16 v19, v143, v143
    s_nop 1
    v_mov_b32 v22, v18
    v_mov_b32 v23, v19
    v_mov_b32 v20, 0x3b124925
    v_permlane32_swap_b32 v18, v22
    v_permlane32_swap_b32 v19, v23
    v_add_f32 v18, v18, v22
    v_add_f32 v19, v19, v23
    v_mul_f32 v176, 0xbb124925, v18
    v_mul_f32 v22, v176, v176
    v_fma_f32 v21, v19, v20, -v22
    v_max_f32 v21, 0, v21
    v_add_f32 v21, 0x3727c5ac, v21
    v_rsq_f32 v20, v21
    v_mov_b32 v177, v176
    ds_write_b32 v6, v20
    ds_read_b128 v[240:243], v7 offset:0
    ds_read_b128 v[244:247], v7 offset:32
    ds_read_b128 v[248:251], v7 offset:64
    ds_read_b128 v[252:255], v7 offset:96
    v_pk_mul_f32 v[178:179], v[176:177], 1.0 op_sel_hi:[1,0]
    v_pk_mul_f32 v[180:181], v[176:177], 1.0 op_sel_hi:[1,0]
    v_pk_mul_f32 v[182:183], v[176:177], 1.0 op_sel_hi:[1,0]
    v_pk_mul_f32 v[184:185], v[176:177], 1.0 op_sel_hi:[1,0]
    v_pk_mul_f32 v[186:187], v[176:177], 1.0 op_sel_hi:[1,0]
    v_pk_mul_f32 v[188:189], v[176:177], 1.0 op_sel_hi:[1,0]
    v_pk_mul_f32 v[190:191], v[176:177], 1.0 op_sel_hi:[1,0]
    v_mul_f32 v20, 0xbfb8aa3b, v20
    s_nop 0
    v_mfma_f32_32x32x16_bf16 v[144:159], v[24:27], v[32:35], v[176:191]
    s_waitcnt lgkmcnt(3)
    v_mul_f32 v240, v240, v224
    v_mul_f32 v241, v241, v225
    v_mul_f32 v242, v242, v226
    v_mul_f32 v243, v243, v227
    s_waitcnt lgkmcnt(2)
    v_mul_f32 v244, v244, v228
    v_mul_f32 v245, v245, v229
    v_mfma_f32_32x32x16_bf16 v[144:159], v[28:31], v[36:39], v[144:159]
    v_mul_f32 v246, v246, v230
    v_mul_f32 v247, v247, v231
    s_waitcnt lgkmcnt(1)
    v_mul_f32 v248, v248, v232
    v_mul_f32 v249, v249, v233
    v_mul_f32 v250, v250, v234
    v_mul_f32 v251, v251, v235
    v_mfma_f32_32x32x16_bf16 v[160:175], v[24:27], v[40:43], v[176:191]
    s_waitcnt lgkmcnt(0)
    v_mul_f32 v252, v252, v236
    v_mul_f32 v253, v253, v237
    v_mul_f32 v254, v254, v238
    v_mul_f32 v255, v255, v239
    v_cvt_pk_bf16_f32 v224, v240, v241
    v_cvt_pk_bf16_f32 v225, v242, v243
    v_mfma_f32_32x32x16_bf16 v[160:175], v[28:31], v[44:47], v[160:175]
    v_cvt_pk_bf16_f32 v226, v244, v245
    v_cvt_pk_bf16_f32 v227, v246, v247
    v_cvt_pk_bf16_f32 v228, v248, v249
    v_cvt_pk_bf16_f32 v229, v250, v251
    v_cvt_pk_bf16_f32 v230, v252, v253
    v_cvt_pk_bf16_f32 v231, v254, v255
    v_mfma_f32_32x32x16_bf16 v[192:207], v[24:27], v[48:51], v[176:191]
    v_xor_b32_dpp v232, v224, v0 quad_perm:[1,0,3,2] row_mask:0xf bank_mask:0xf
    v_xor_b32_dpp v233, v225, v0 quad_perm:[1,0,3,2] row_mask:0xf bank_mask:0xf
    v_xor_b32_dpp v234, v226, v0 quad_perm:[1,0,3,2] row_mask:0xf bank_mask:0xf
    v_xor_b32_dpp v235, v227, v0 quad_perm:[1,0,3,2] row_mask:0xf bank_mask:0xf
    v_xor_b32_dpp v236, v228, v0 quad_perm:[1,0,3,2] row_mask:0xf bank_mask:0xf
    v_xor_b32_dpp v237, v229, v0 quad_perm:[1,0,3,2] row_mask:0xf bank_mask:0xf
    v_mfma_f32_32x32x16_bf16 v[192:207], v[28:31], v[52:55], v[192:207]
    v_xor_b32_dpp v238, v230, v0 quad_perm:[1,0,3,2] row_mask:0xf bank_mask:0xf
    v_xor_b32_dpp v239, v231, v0 quad_perm:[1,0,3,2] row_mask:0xf bank_mask:0xf
    v_mfma_f32_32x32x16_bf16 v[240:255], v[208:211], v[224:227], 0
    v_cvt_pk_bf16_f32 v32, v144, v145
    v_cvt_pk_bf16_f32 v33, v146, v147
    v_cvt_pk_bf16_f32 v34, v148, v149
    v_cvt_pk_bf16_f32 v35, v150, v151
    v_cvt_pk_bf16_f32 v36, v152, v153
    v_cvt_pk_bf16_f32 v37, v154, v155
    v_mfma_f32_32x32x16_bf16 v[240:255], v[212:215], v[228:231], v[240:255]
    v_cvt_pk_bf16_f32 v38, v156, v157
    v_cvt_pk_bf16_f32 v39, v158, v159
    v_cvt_pk_bf16_f32 v40, v160, v161
    v_cvt_pk_bf16_f32 v41, v162, v163
    v_cvt_pk_bf16_f32 v42, v164, v165
    v_cvt_pk_bf16_f32 v43, v166, v167
    v_mfma_f32_32x32x16_bf16 v[240:255], v[216:219], v[232:235], v[240:255]
    v_cvt_pk_bf16_f32 v44, v168, v169
    v_cvt_pk_bf16_f32 v45, v170, v171
    v_cvt_pk_bf16_f32 v46, v172, v173
    v_cvt_pk_bf16_f32 v47, v174, v175
    v_mfma_f32_32x32x16_bf16 v[240:255], v[220:223], v[236:239], v[240:255]
    v_mfma_f32_32x32x16_bf16 v[144:159], v[24:27], v[56:59], v[176:191]
    v_cvt_pk_bf16_f32 v48, v192, v193
    v_cvt_pk_bf16_f32 v49, v194, v195
    v_cvt_pk_bf16_f32 v50, v196, v197
    v_cvt_pk_bf16_f32 v51, v198, v199
    v_cvt_pk_bf16_f32 v52, v200, v201
    v_cvt_pk_bf16_f32 v53, v202, v203
    v_mfma_f32_32x32x16_bf16 v[144:159], v[28:31], v[60:63], v[144:159]
    s_nop 1
    v_cvt_pk_bf16_f32 v54, v204, v205
    v_cvt_pk_bf16_f32 v55, v206, v207
    v_cvt_pk_bf16_f32 v224, v240, v241
    v_cvt_pk_bf16_f32 v225, v242, v243
    v_cvt_pk_bf16_f32 v226, v244, v245
    v_mfma_f32_32x32x16_bf16 v[160:175], v[24:27], v[64:67], v[176:191]
    v_cvt_pk_bf16_f32 v227, v246, v247
    v_cvt_pk_bf16_f32 v228, v248, v249
    v_cvt_pk_bf16_f32 v229, v250, v251
    v_cvt_pk_bf16_f32 v230, v252, v253
    v_cvt_pk_bf16_f32 v231, v254, v255
    v_mfma_f32_32x32x16_bf16 v[160:175], v[28:31], v[68:71], v[160:175]
    buffer_store_dwordx4 v[224:227], v4, s[24:27], s71 offen sc1
    buffer_store_dwordx4 v[228:231], v5, s[24:27], s71 offen offset:256 sc1
    v_and_b32 v6, 12, v3
    v_and_b32 v7, 16, v3
    v_lshl_add_u32 v6, v7, 3, v6
    v_mfma_f32_32x32x16_bf16 v[192:207], v[24:27], v[72:75], v[176:191]
    buffer_load_dword v0, v6, s[32:35], 0 offen sc1
    v_cvt_pk_bf16_f32 v56, v144, v145
    v_cvt_pk_bf16_f32 v57, v146, v147
    v_cvt_pk_bf16_f32 v58, v148, v149
    v_cvt_pk_bf16_f32 v59, v150, v151
    v_mfma_f32_32x32x16_bf16 v[192:207], v[28:31], v[76:79], v[192:207]
    s_add_u32 m0, s42, 32768
    s_nop 0
    buffer_load_dwordx4 v12, s[12:15], s53 offen lds
    v_cvt_pk_bf16_f32 v60, v152, v153
    v_cvt_pk_bf16_f32 v61, v154, v155
    v_cvt_pk_bf16_f32 v62, v156, v157
    v_cvt_pk_bf16_f32 v63, v158, v159
    v_mfma_f32_32x32x16_bf16 v[144:159], v[24:27], v[80:83], v[176:191]
    v_cvt_pk_bf16_f32 v64, v160, v161
    v_cvt_pk_bf16_f32 v65, v162, v163
    v_cvt_pk_bf16_f32 v66, v164, v165
    v_cvt_pk_bf16_f32 v67, v166, v167
    v_min_u32 v241, 1, v3
    v_lshlrev_b32 v241, 30, v241
    v_mfma_f32_32x32x16_bf16 v[144:159], v[28:31], v[84:87], v[144:159]
    buffer_load_dwordx4 v13, s[12:15], s53 offen offset:1024 lds
    v_cvt_pk_bf16_f32 v68, v168, v169
    v_cvt_pk_bf16_f32 v69, v170, v171
    v_cvt_pk_bf16_f32 v70, v172, v173
    v_cvt_pk_bf16_f32 v71, v174, v175
    v_mfma_f32_32x32x16_bf16 v[160:175], v[24:27], v[88:91], v[176:191]
    v_cvt_pk_bf16_f32 v72, v192, v193
    v_cvt_pk_bf16_f32 v73, v194, v195
    v_cvt_pk_bf16_f32 v74, v196, v197
    v_cvt_pk_bf16_f32 v75, v198, v199
    v_mov_b32 v240, 0
    v_mfma_f32_32x32x16_bf16 v[160:175], v[28:31], v[92:95], v[160:175]
    s_add_u32 m0, s42, 49152
    s_nop 0
    buffer_load_dwordx4 v12, s[12:15], s54 offen lds
    v_cvt_pk_bf16_f32 v76, v200, v201
    v_cvt_pk_bf16_f32 v77, v202, v203
    v_cvt_pk_bf16_f32 v78, v204, v205
    v_cvt_pk_bf16_f32 v79, v206, v207
    v_mfma_f32_32x32x16_bf16 v[192:207], v[24:27], v[96:99], v[176:191]
    s_lshl_b32 s70, s5, 2
    s_lshr_b32 s38, s6, 4
    s_add_u32 s70, s70, s38
    v_cvt_pk_bf16_f32 v80, v144, v145
    v_cvt_pk_bf16_f32 v81, v146, v147
    v_cvt_pk_bf16_f32 v82, v148, v149
    v_cvt_pk_bf16_f32 v83, v150, v151
    v_mfma_f32_32x32x16_bf16 v[192:207], v[28:31], v[100:103], v[192:207]
    buffer_load_dwordx4 v13, s[12:15], s54 offen offset:1024 lds
    v_cvt_pk_bf16_f32 v84, v152, v153
    v_cvt_pk_bf16_f32 v85, v154, v155
    v_cvt_pk_bf16_f32 v86, v156, v157
    v_cvt_pk_bf16_f32 v87, v158, v159
    v_mfma_f32_32x32x16_bf16 v[144:159], v[24:27], v[104:107], v[176:191]
    s_mul_i32 s70, s70, 4352
    s_and_b32 s38, s6, 15
    s_add_u32 s70, s70, s38
    v_cvt_pk_bf16_f32 v88, v160, v161
    v_cvt_pk_bf16_f32 v89, v162, v163
    v_cvt_pk_bf16_f32 v90, v164, v165
    v_cvt_pk_bf16_f32 v91, v166, v167
    v_mfma_f32_32x32x16_bf16 v[144:159], v[28:31], v[108:111], v[144:159]
    s_add_u32 m0, s42, 65536
    s_nop 0
    buffer_load_dwordx4 v12, s[12:15], s55 offen lds
    v_cvt_pk_bf16_f32 v92, v168, v169
    v_cvt_pk_bf16_f32 v93, v170, v171
    v_cvt_pk_bf16_f32 v94, v172, v173
    v_cvt_pk_bf16_f32 v95, v174, v175
    v_mfma_f32_32x32x16_bf16 v[160:175], v[24:27], v[112:115], v[176:191]
    s_add_u32 s70, s70, 835584
    s_mov_b32 s22, 1605632
    s_mov_b32 s23, 0x20000
    v_cvt_pk_bf16_f32 v96, v192, v193
    v_cvt_pk_bf16_f32 v97, v194, v195
    v_cvt_pk_bf16_f32 v98, v196, v197
    v_cvt_pk_bf16_f32 v99, v198, v199
    v_mfma_f32_32x32x16_bf16 v[160:175], v[28:31], v[116:119], v[160:175]
    buffer_load_dwordx4 v13, s[12:15], s55 offen offset:1024 lds
    v_cvt_pk_bf16_f32 v100, v200, v201
    v_cvt_pk_bf16_f32 v101, v202, v203
    v_cvt_pk_bf16_f32 v102, v204, v205
    v_cvt_pk_bf16_f32 v103, v206, v207
    v_mfma_f32_32x32x16_bf16 v[192:207], v[24:27], v[120:123], v[176:191]
    s_waitcnt vmcnt(15)
    s_barrier
    ds_read_b64_tr_b16 a[0:1], v14 offset:0
    ds_read_b64_tr_b16 a[2:3], v14 offset:1024
    v_cvt_pk_bf16_f32 v104, v144, v145
    v_cvt_pk_bf16_f32 v105, v146, v147
    v_cvt_pk_bf16_f32 v106, v148, v149
    v_cvt_pk_bf16_f32 v107, v150, v151
    v_mfma_f32_32x32x16_bf16 v[192:207], v[28:31], v[124:127], v[192:207]
    s_add_u32 m0, s42, 81920
    s_nop 0
    buffer_load_dwordx4 v12, s[12:15], s56 offen lds
    ds_read_b64_tr_b16 a[4:5], v15 offset:0
    ds_read_b64_tr_b16 a[6:7], v15 offset:1024
    v_cvt_pk_bf16_f32 v108, v152, v153
    v_cvt_pk_bf16_f32 v109, v154, v155
    v_cvt_pk_bf16_f32 v110, v156, v157
    v_cvt_pk_bf16_f32 v111, v158, v159
    v_mfma_f32_32x32x16_bf16 v[144:159], v[24:27], v[128:131], v[176:191]
    ds_read_b64_tr_b16 a[8:9], v14 offset:4096
    ds_read_b64_tr_b16 a[10:11], v14 offset:5120
    v_cvt_pk_bf16_f32 v112, v160, v161
    v_cvt_pk_bf16_f32 v113, v162, v163
    v_cvt_pk_bf16_f32 v114, v164, v165
    v_cvt_pk_bf16_f32 v115, v166, v167
    v_mfma_f32_32x32x16_bf16 v[144:159], v[28:31], v[132:135], v[144:159]
    buffer_load_dwordx4 v13, s[12:15], s56 offen offset:1024 lds
    ds_read_b64_tr_b16 a[12:13], v15 offset:4096
    ds_read_b64_tr_b16 a[14:15], v15 offset:5120
    v_cvt_pk_bf16_f32 v116, v168, v169
    v_cvt_pk_bf16_f32 v117, v170, v171
    v_cvt_pk_bf16_f32 v118, v172, v173
    v_cvt_pk_bf16_f32 v119, v174, v175
    v_mfma_f32_32x32x16_bf16 v[160:175], v[24:27], v[136:139], v[176:191]
    ds_read_b64_tr_b16 a[16:17], v14 offset:8192
    ds_read_b64_tr_b16 a[18:19], v14 offset:9216
    v_cvt_pk_bf16_f32 v120, v192, v193
    v_cvt_pk_bf16_f32 v121, v194, v195
    v_cvt_pk_bf16_f32 v122, v196, v197
    v_cvt_pk_bf16_f32 v123, v198, v199
    v_mfma_f32_32x32x16_bf16 v[160:175], v[28:31], v[140:143], v[160:175]
    s_waitcnt lgkmcnt(6)
    ds_read_b64_tr_b16 a[20:21], v15 offset:8192
    ds_read_b64_tr_b16 a[22:23], v15 offset:9216
    v_cvt_pk_bf16_f32 v124, v200, v201
    v_cvt_pk_bf16_f32 v125, v202, v203
    v_cvt_pk_bf16_f32 v126, v204, v205
    v_cvt_pk_bf16_f32 v127, v206, v207
    v_mfma_f32_32x32x16_bf16 v[208:223], a[0:3], v[32:35], 0
    s_add_u32 m0, s42, 98304
    s_mul_i32 s38, s4, 2
    s_mul_i32 s39, s7, 1
    ds_read_b64_tr_b16 a[24:25], v14 offset:12288
    ds_read_b64_tr_b16 a[26:27], v14 offset:13312
    buffer_load_dwordx4 v12, s[12:15], s57 offen lds
    v_mfma_f32_32x32x16_bf16 v[224:239], a[4:7], v[32:35], 0
    s_waitcnt lgkmcnt(6)
    s_add_u32 s38, s38, s39
    s_and_b32 s38, s38, 3
    s_mul_i32 s58, s38, 229376
    s_lshr_b32 s40, s3, 1
    ds_read_b64_tr_b16 a[28:29], v15 offset:12288
    ds_read_b64_tr_b16 a[30:31], v15 offset:13312
    v_mfma_f32_32x32x16_bf16 v[208:223], a[8:11], v[36:39], v[208:223]
    s_waitcnt vmcnt(16)
    s_barrier
    s_mul_i32 s40, s40, 802816
    ds_read_b64_tr_b16 a[0:1], v14 offset:16384
    ds_read_b64_tr_b16 a[2:3], v14 offset:17408
    buffer_load_dwordx4 v13, s[12:15], s57 offen offset:1024 lds
    v_mfma_f32_32x32x16_bf16 v[224:239], a[12:15], v[36:39], v[224:239]
    s_waitcnt lgkmcnt(6)
    s_lshl_b32 s41, s37, 1
    s_and_b32 s38, s3, 1
    s_add_u32 s41, s41, s38
    s_mul_i32 s38, s41, 14336
    ds_read_b64_tr_b16 a[4:5], v15 offset:16384
    ds_read_b64_tr_b16 a[6:7], v15 offset:17408
    v_mfma_f32_32x32x16_bf16 v[208:223], a[16:19], v[40:43], v[208:223]
    s_add_u32 m0, s42, 34816
    ds_read_b64_tr_b16 a[8:9], v14 offset:20480
    ds_read_b64_tr_b16 a[10:11], v14 offset:21504
    buffer_load_dwordx4 v12, s[16:19], s53 offen lds
    s_waitcnt vmcnt(11)
    v_cmp_ne_u32 vcc, 0x01010101, v0
    s_nop 0
    s_cbranch_vccnz L_slow5
L_back5:
    v_mfma_f32_32x32x16_bf16 v[224:239], a[20:23], v[40:43], v[224:239]
    s_waitcnt lgkmcnt(6)
    s_add_u32 s38, s38, s40
    ds_read_b64_tr_b16 a[12:13], v15 offset:20480
    ds_read_b64_tr_b16 a[14:15], v15 offset:21504
    buffer_store_byte v240, v241, s[24:27], s70 offen sc1
    v_mov_b32 v240, 14
    v_mfma_f32_32x32x16_bf16 v[208:223], a[24:27], v[44:47], v[208:223]
    s_lshl_b32 s39, s7, 7
    s_add_u32 s38, s38, s39
    ds_read_b64_tr_b16 a[16:17], v14 offset:24576
    ds_read_b64_tr_b16 a[18:19], v14 offset:25600
    buffer_load_dwordx4 v13, s[16:19], s53 offen offset:1024 lds
    v_and_b32 v22, 0x70, v12
    v_mfma_f32_32x32x16_bf16 v[224:239], a[28:31], v[44:47], v[224:239]
    s_waitcnt lgkmcnt(6)
    ds_read_b64_tr_b16 a[20:21], v15 offset:24576
    ds_read_b64_tr_b16 a[22:23], v15 offset:25600
    v_lshrrev_b32 v23, 3, v3
    v_mul_u32_u24 v23, 896, v23
    v_add3_u32 v4, v22, v23, s38
    v_add_u32 v5, 6144, v4
    v_mfma_f32_32x32x16_bf16 v[208:223], a[0:3], v[48:51], v[208:223]
    s_add_u32 m0, s42, 51200
    s_mul_i32 s43, s3, 12288
    s_add_u32 s43, s43, 114688
    ds_read_b64_tr_b16 a[24:25], v14 offset:28672
    ds_read_b64_tr_b16 a[26:27], v14 offset:29696
    buffer_load_dwordx4 v12, s[16:19], s54 offen lds
    v_mfma_f32_32x32x16_bf16 v[224:239], a[4:7], v[48:51], v[224:239]
    s_waitcnt lgkmcnt(6)
    s_add_u32 s59, s58, 114688
    s_sub_u32 s38, s59, 802816
    s_min_u32 s59, s59, s38
    s_add_u32 s60, s58, 229376
    ds_read_b64_tr_b16 a[28:29], v15 offset:28672
    ds_read_b64_tr_b16 a[30:31], v15 offset:29696
    v_mfma_f32_32x32x16_bf16 v[208:223], a[8:11], v[52:55], v[208:223]
    s_waitcnt vmcnt(10)
    s_barrier
    s_sub_u32 s38, s60, 802816
    ds_read_b64_tr_b16 a[0:1], v14 offset:32768
    ds_read_b64_tr_b16 a[2:3], v14 offset:33792
    buffer_load_dwordx4 v13, s[16:19], s54 offen offset:1024 lds
    v_mfma_f32_32x32x16_bf16 v[224:239], a[12:15], v[52:55], v[224:239]
    s_waitcnt lgkmcnt(6)
    s_min_u32 s60, s60, s38
    s_add_u32 s61, s58, 344064
    s_sub_u32 s38, s61, 802816
    s_min_u32 s61, s61, s38
    ds_read_b64_tr_b16 a[4:5], v15 offset:32768
    ds_read_b64_tr_b16 a[6:7], v15 offset:33792
    v_mfma_f32_32x32x16_bf16 v[208:223], a[16:19], v[56:59], v[208:223]
    s_add_u32 m0, s42, 67584
    s_add_u32 s62, s58, 458752
    s_sub_u32 s38, s62, 802816
    ds_read_b64_tr_b16 a[8:9], v14 offset:36864
    ds_read_b64_tr_b16 a[10:11], v14 offset:37888
    buffer_load_dwordx4 v12, s[16:19], s55 offen lds
    v_mfma_f32_32x32x16_bf16 v[224:239], a[20:23], v[56:59], v[224:239]
    s_waitcnt lgkmcnt(6)
    s_min_u32 s62, s62, s38
    s_add_u32 s63, s58, 573440
    s_sub_u32 s38, s63, 802816
    s_min_u32 s63, s63, s38
    ds_read_b64_tr_b16 a[12:13], v15 offset:36864
    ds_read_b64_tr_b16 a[14:15], v15 offset:37888
    v_mfma_f32_32x32x16_bf16 v[208:223], a[24:27], v[60:63], v[208:223]
    s_add_u32 s64, s58, 688128
    s_sub_u32 s38, s64, 802816
    s_min_u32 s64, s64, s38
    ds_read_b64_tr_b16 a[16:17], v14 offset:40960
    ds_read_b64_tr_b16 a[18:19], v14 offset:41984
    buffer_load_dwordx4 v13, s[16:19], s55 offen offset:1024 lds
    v_mfma_f32_32x32x16_bf16 v[224:239], a[28:31], v[60:63], v[224:239]
    s_waitcnt lgkmcnt(6)
    ds_read_b64_tr_b16 a[20:21], v15 offset:40960
    ds_read_b64_tr_b16 a[22:23], v15 offset:41984
    v_cvt_pk_bf16_f32 v128, v144, v145
    v_cvt_pk_bf16_f32 v129, v146, v147
    v_cvt_pk_bf16_f32 v130, v148, v149
    v_cvt_pk_bf16_f32 v131, v150, v151
    v_mfma_f32_32x32x16_bf16 v[208:223], a[0:3], v[64:67], v[208:223]
    s_add_u32 m0, s42, 83968
    ds_read_b64_tr_b16 a[24:25], v14 offset:45056
    ds_read_b64_tr_b16 a[26:27], v14 offset:46080
    buffer_load_dwordx4 v12, s[16:19], s56 offen lds
    v_cvt_pk_bf16_f32 v132, v152, v153
    v_cvt_pk_bf16_f32 v133, v154, v155
    v_mfma_f32_32x32x16_bf16 v[224:239], a[4:7], v[64:67], v[224:239]
    s_waitcnt lgkmcnt(6)
    ds_read_b64_tr_b16 a[28:29], v15 offset:45056
    ds_read_b64_tr_b16 a[30:31], v15 offset:46080
    v_cvt_pk_bf16_f32 v134, v156, v157
    v_cvt_pk_bf16_f32 v135, v158, v159
    v_cvt_pk_bf16_f32 v136, v160, v161
    v_cvt_pk_bf16_f32 v137, v162, v163
    v_mfma_f32_32x32x16_bf16 v[208:223], a[8:11], v[68:71], v[208:223]
    ds_read_b64_tr_b16 a[0:1], v14 offset:49152
    ds_read_b64_tr_b16 a[2:3], v14 offset:50176
    buffer_load_dwordx4 v13, s[16:19], s56 offen offset:1024 lds
    v_cvt_pk_bf16_f32 v138, v164, v165
    v_cvt_pk_bf16_f32 v139, v166, v167
    v_mfma_f32_32x32x16_bf16 v[224:239], a[12:15], v[68:71], v[224:239]
    s_waitcnt lgkmcnt(6)
    ds_read_b64_tr_b16 a[4:5], v14 offset:53248
    ds_read_b64_tr_b16 a[6:7], v14 offset:54272
    v_cvt_pk_bf16_f32 v140, v168, v169
    v_cvt_pk_bf16_f32 v141, v170, v171
    v_cvt_pk_bf16_f32 v142, v172, v173
    v_cvt_pk_bf16_f32 v143, v174, v175
    v_mfma_f32_32x32x16_bf16 v[208:223], a[16:19], v[72:75], v[208:223]
    s_add_u32 m0, s42, 100352
    ds_read_b64_tr_b16 a[8:9], v14 offset:57344
    ds_read_b64_tr_b16 a[10:11], v14 offset:58368
    buffer_load_dwordx4 v12, s[16:19], s57 offen lds
    v_xor_b32 v10, s73, v14
    v_xor_b32 v11, s73, v15
    v_mfma_f32_32x32x16_bf16 v[224:239], a[20:23], v[72:75], v[224:239]
    s_waitcnt lgkmcnt(6)
    ds_read_b64_tr_b16 a[12:13], v14 offset:61440
    ds_read_b64_tr_b16 a[14:15], v14 offset:62464
    v_add_u32 v8, s43, v10
    v_add_u32 v9, s43, v11
    v_add_u32 v10, s42, v10
    v_add_u32 v11, s42, v11
    v_mfma_f32_32x32x16_bf16 v[208:223], a[24:27], v[76:79], v[208:223]
    s_waitcnt vmcnt(10)
    s_barrier
    ds_read_b64_tr_b16 a[16:17], v16 offset:0
    ds_read_b64_tr_b16 a[18:19], v16 offset:1024
    buffer_load_dwordx4 v13, s[16:19], s57 offen offset:1024 lds
    v_xor_b32 v12, 128, v12
    v_xor_b32 v13, 128, v13
    v_mfma_f32_32x32x16_bf16 v[224:239], a[28:31], v[76:79], v[224:239]
    s_waitcnt lgkmcnt(6)
    s_lshl_b32 s41, s41, 13
    s_add_u32 s40, s40, s41
    s_lshr_b32 s41, s36, 2
    s_mul_i32 s41, s41, 1605632
    ds_read_b64_tr_b16 a[20:21], v16 offset:4096
    ds_read_b64_tr_b16 a[22:23], v16 offset:5120
    v_mfma_f32_32x32x16_bf16 v[208:223], a[0:3], v[80:83], v[208:223]
    s_add_u32 m0, s43, 0
    s_add_u32 s41, s41, 8388608
    s_add_u32 s40, s40, s41
    ds_read_b64_tr_b16 a[24:25], v16 offset:8192
    ds_read_b64_tr_b16 a[26:27], v16 offset:9216
    buffer_load_dwordx4 v4, s[20:23], s58 offen lds
    v_mfma_f32_32x32x16_bf16 v[208:223], a[4:7], v[84:87], v[208:223]
    s_waitcnt lgkmcnt(6)
    s_and_b32 s38, s36, 3
    s_lshl_b32 s38, s38, 11
    s_add_u32 s40, s40, s38
    ds_read_b64_tr_b16 a[28:29], v16 offset:12288
    ds_read_b64_tr_b16 a[30:31], v16 offset:13312
    v_lshl_add_u32 v6, v3, 4, s40
    v_mfma_f32_32x32x16_bf16 v[208:223], a[8:11], v[88:91], v[208:223]
    s_mul_i32 s40, s5, 114688
    s_add_u32 s40, s40, s41
    s_and_b32 s38, s6, 7
    ds_read_b64_tr_b16 a[0:1], v16 offset:16384
    ds_read_b64_tr_b16 a[2:3], v16 offset:17408
    buffer_load_dwordx4 v5, s[20:23], s58 offen offset:1024 lds
    v_mfma_f32_32x32x16_bf16 v[208:223], a[12:15], v[92:95], v[208:223]
    s_waitcnt lgkmcnt(6)
    s_lshl_b32 s38, s38, 10
    s_add_u32 s40, s40, s38
    s_lshl_b32 s38, s37, 14
    s_add_u32 s40, s40, s38
    ds_read_b64_tr_b16 a[4:5], v16 offset:20480
    ds_read_b64_tr_b16 a[6:7], v16 offset:21504
    v_mfma_f32_32x32x16_bf16 v[208:223], a[16:19], v[96:99], v[208:223]
    s_add_u32 m0, s43, 2048
    ds_read_b64_tr_b16 a[8:9], v16 offset:24576
    ds_read_b64_tr_b16 a[10:11], v16 offset:25600
    buffer_load_dwordx4 v4, s[20:23], s59 offen lds
    v_lshl_add_u32 v7, v3, 4, s40
    v_mfma_f32_32x32x16_bf16 v[208:223], a[20:23], v[100:103], v[208:223]
    s_waitcnt lgkmcnt(6)
    s_xor_b32 s38, s37, 1
    s_xor_b32 s39, s37, 2
    s_sub_u32 s39, s39, s38
    s_sub_u32 s38, s38, s37
    ds_read_b64_tr_b16 a[12:13], v16 offset:28672
    ds_read_b64_tr_b16 a[14:15], v16 offset:29696
    v_mfma_f32_32x32x16_bf16 v[208:223], a[24:27], v[104:107], v[208:223]
    s_mul_i32 s65, s38, 28672
    s_mul_i32 s66, s39, 28672
    s_lshl_b32 s67, s38, 14
    ds_read_b64_tr_b16 a[16:17], v16 offset:32768
    ds_read_b64_tr_b16 a[18:19], v16 offset:33792
    buffer_load_dwordx4 v5, s[20:23], s59 offen offset:1024 lds
    v_mfma_f32_32x32x16_bf16 v[208:223], a[28:31], v[108:111], v[208:223]
    s_waitcnt lgkmcnt(6)
    s_lshl_b32 s68, s39, 14
    s_mov_b32 s69, 8192
    s_and_b32 s71, s6, 62
    s_and_b32 s38, s2, 1
    ds_read_b64_tr_b16 a[20:21], v16 offset:36864
    ds_read_b64_tr_b16 a[22:23], v16 offset:37888
    v_mfma_f32_32x32x16_bf16 v[208:223], a[0:3], v[112:115], v[208:223]
    s_add_u32 m0, s43, 4096
    s_add_u32 s71, s71, s38
    s_mul_i32 s71, s71, 4352
    ds_read_b64_tr_b16 a[24:25], v16 offset:40960
    ds_read_b64_tr_b16 a[26:27], v16 offset:41984
    buffer_load_dwordx4 v4, s[20:23], s60 offen lds
    v_mfma_f32_32x32x16_bf16 v[208:223], a[4:7], v[116:119], v[208:223]
    s_waitcnt lgkmcnt(6)
    s_and_b32 s38, s6, 1
    s_lshl_b32 s38, s38, 3
    s_add_u32 s71, s71, s38
    s_add_u32 s71, s71, s7
    ds_read_b64_tr_b16 a[28:29], v16 offset:45056
    ds_read_b64_tr_b16 a[30:31], v16 offset:46080
    v_mfma_f32_32x32x16_bf16 v[208:223], a[8:11], v[120:123], v[208:223]
    s_waitcnt vmcnt(13)
    s_barrier
    ds_read_b64_tr_b16 a[0:1], v14 offset:2048
    ds_read_b64_tr_b16 a[2:3], v14 offset:3072
    buffer_load_dwordx4 v5, s[20:23], s60 offen offset:1024 lds
    v_lshrrev_b32 v22, 2, v3
    v_mfma_f32_32x32x16_bf16 v[208:223], a[12:15], v[124:127], v[208:223]
    s_waitcnt lgkmcnt(6)
    ds_read_b64_tr_b16 a[4:5], v14 offset:6144
    ds_read_b64_tr_b16 a[6:7], v14 offset:7168
    v_lshlrev_b32 v243, 2, v3
    v_lshl_add_u32 v243, v22, 28, v243
    v_mfma_f32_32x32x16_bf16 v[208:223], a[16:19], v[128:131], v[208:223]
    s_add_u32 m0, s43, 6144
    s_lshl_b32 s48, s36, 1
    s_lshr_b32 s38, s3, 1
    ds_read_b64_tr_b16 a[8:9], v14 offset:10240
    ds_read_b64_tr_b16 a[10:11], v14 offset:11264
    buffer_load_dwordx4 v4, s[20:23], s61 offen lds
    v_mfma_f32_32x32x16_bf16 v[208:223], a[20:23], v[132:135], v[208:223]
    s_waitcnt lgkmcnt(6)
    s_add_u32 s48, s48, s38
    s_mul_i32 s48, s48, 4352
    s_lshl_b32 s49, s36, 2
    s_add_u32 s49, s49, s3
    ds_read_b64_tr_b16 a[12:13], v14 offset:14336
    ds_read_b64_tr_b16 a[14:15], v14 offset:15360
    v_mfma_f32_32x32x16_bf16 v[208:223], a[24:27], v[136:139], v[208:223]
    s_mul_i32 s49, s49, 4352
    s_add_u32 s49, s49, 278528
    s_mov_b32 s30, 1835008
    ds_read_b64_tr_b16 a[16:17], v14 offset:18432
    ds_read_b64_tr_b16 a[18:19], v14 offset:19456
    buffer_load_dwordx4 v5, s[20:23], s61 offen offset:1024 lds
    v_mfma_f32_32x32x16_bf16 v[208:223], a[28:31], v[140:143], v[208:223]
    s_waitcnt lgkmcnt(6)
    s_mov_b32 s31, 0x20000
    ds_read_b64_tr_b16 a[20:21], v14 offset:22528
    ds_read_b64_tr_b16 a[22:23], v14 offset:23552
    v_mfma_f32_32x32x16_bf16 v[176:191], a[0:3], v[32:35], 0
    s_add_u32 m0, s43, 8192
    ds_read_b64_tr_b16 a[24:25], v14 offset:26624
    ds_read_b64_tr_b16 a[26:27], v14 offset:27648
    buffer_load_dwordx4 v4, s[20:23], s62 offen lds
    v_mfma_f32_32x32x16_bf16 v[176:191], a[4:7], v[36:39], v[176:191]
    s_waitcnt lgkmcnt(6)
    ds_read_b64_tr_b16 a[28:29], v14 offset:30720
    ds_read_b64_tr_b16 a[30:31], v14 offset:31744
    v_mfma_f32_32x32x16_bf16 v[176:191], a[8:11], v[40:43], v[176:191]
    ds_read_b64_tr_b16 a[0:1], v14 offset:34816
    ds_read_b64_tr_b16 a[2:3], v14 offset:35840
    buffer_load_dwordx4 v5, s[20:23], s62 offen offset:1024 lds
    v_mul_f32 v24, v20, v208
    v_mul_f32 v25, v20, v209
    v_mfma_f32_32x32x16_bf16 v[176:191], a[12:15], v[44:47], v[176:191]
    s_waitcnt lgkmcnt(6)
    ds_read_b64_tr_b16 a[4:5], v14 offset:38912
    ds_read_b64_tr_b16 a[6:7], v14 offset:39936
    v_exp_f32 v24, v24
    v_exp_f32 v25, v25
    v_mfma_f32_32x32x16_bf16 v[176:191], a[16:19], v[48:51], v[176:191]
    s_add_u32 m0, s43, 10240
    ds_read_b64_tr_b16 a[8:9], v14 offset:43008
    ds_read_b64_tr_b16 a[10:11], v14 offset:44032
    buffer_load_dwordx4 v4, s[20:23], s63 offen lds
    v_fma_f32 v24, v24, v21, v21
    v_fma_f32 v25, v25, v21, v21
    v_mfma_f32_32x32x16_bf16 v[176:191], a[20:23], v[52:55], v[176:191]
    s_waitcnt lgkmcnt(6)
    ds_read_b64_tr_b16 a[12:13], v14 offset:47104
    ds_read_b64_tr_b16 a[14:15], v14 offset:48128
    v_rcp_f32 v24, v24
    v_rcp_f32 v25, v25
    v_mfma_f32_32x32x16_bf16 v[176:191], a[24:27], v[56:59], v[176:191]
    s_waitcnt vmcnt(13)
    s_barrier
    ds_read_b64_tr_b16 a[16:17], v14 offset:51200
    ds_read_b64_tr_b16 a[18:19], v14 offset:52224
    buffer_load_dwordx4 v5, s[20:23], s63 offen offset:1024 lds
    v_mul_f32 v208, v24, v208
    v_mfma_f32_32x32x16_bf16 v[176:191], a[28:31], v[60:63], v[176:191]
    s_waitcnt lgkmcnt(6)
    ds_read_b64_tr_b16 a[20:21], v14 offset:55296
    ds_read_b64_tr_b16 a[22:23], v14 offset:56320
    v_mul_f32 v209, v25, v209
    v_mul_f32 v26, v20, v210
    v_mul_f32 v27, v20, v211
    v_mul_f32 v28, v20, v212
    v_mfma_f32_32x32x16_bf16 v[176:191], a[0:3], v[64:67], v[176:191]
    s_add_u32 m0, s42, 0
    ds_read_b64_tr_b16 a[24:25], v14 offset:59392
    ds_read_b64_tr_b16 a[26:27], v14 offset:60416
    buffer_load_dwordx4 v12, s[12:15], s51 offen lds
    v_exp_f32 v26, v26
    v_mfma_f32_32x32x16_bf16 v[176:191], a[4:7], v[68:71], v[176:191]
    s_waitcnt lgkmcnt(6)
    ds_read_b64_tr_b16 a[28:29], v14 offset:63488
    ds_read_b64_tr_b16 a[30:31], v14 offset:64512
    v_exp_f32 v27, v27
    v_fma_f32 v26, v26, v21, v21
    v_fma_f32 v27, v27, v21, v21
    v_mfma_f32_32x32x16_bf16 v[176:191], a[8:11], v[72:75], v[176:191]
    ds_read_b64_tr_b16 a[0:1], v16 offset:2048
    ds_read_b64_tr_b16 a[2:3], v16 offset:3072
    buffer_load_dwordx4 v13, s[12:15], s51 offen offset:1024 lds
    v_rcp_f32 v26, v26
    v_mfma_f32_32x32x16_bf16 v[176:191], a[12:15], v[76:79], v[176:191]
    s_waitcnt lgkmcnt(6)
    ds_read_b64_tr_b16 a[4:5], v16 offset:6144
    ds_read_b64_tr_b16 a[6:7], v16 offset:7168
    v_rcp_f32 v27, v27
    v_mul_f32 v210, v26, v210
    v_mul_f32 v211, v27, v211
    v_mfma_f32_32x32x16_bf16 v[176:191], a[16:19], v[80:83], v[176:191]
    s_add_u32 m0, s42, 16384
    ds_read_b64_tr_b16 a[8:9], v16 offset:10240
    ds_read_b64_tr_b16 a[10:11], v16 offset:11264
    buffer_load_dwordx4 v12, s[12:15], s52 offen lds
    v_mul_f32 v29, v20, v213
    v_mul_f32 v30, v20, v214
    v_mfma_f32_32x32x16_bf16 v[176:191], a[20:23], v[84:87], v[176:191]
    s_waitcnt vmcnt(13) lgkmcnt(6)
    ds_read_b64_tr_b16 a[32:33], v8 offset:0
    ds_read_b64_tr_b16 a[34:35], v8 offset:1024
    ds_read_b64_tr_b16 a[12:13], v16 offset:14336
    ds_read_b64_tr_b16 a[14:15], v16 offset:15360
    v_exp_f32 v28, v28
    v_mfma_f32_32x32x16_bf16 v[176:191], a[24:27], v[88:91], v[176:191]
    ds_read_b64_tr_b16 a[16:17], v16 offset:18432
    ds_read_b64_tr_b16 a[18:19], v16 offset:19456
    buffer_load_dwordx4 v13, s[12:15], s52 offen offset:1024 lds
    v_exp_f32 v29, v29
    v_mfma_f32_32x32x16_bf16 v[176:191], a[28:31], v[92:95], v[176:191]
    s_waitcnt lgkmcnt(8)
    ds_read_b64_tr_b16 a[36:37], v9 offset:0
    ds_read_b64_tr_b16 a[38:39], v9 offset:1024
    ds_read_b64_tr_b16 a[20:21], v16 offset:22528
    ds_read_b64_tr_b16 a[22:23], v16 offset:23552
    v_fma_f32 v28, v28, v21, v21
    v_fma_f32 v29, v29, v21, v21
    v_mfma_f32_32x32x16_bf16 v[176:191], a[0:3], v[96:99], v[176:191]
    s_add_u32 m0, s42, 32768
    ds_read_b64_tr_b16 a[24:25], v16 offset:26624
    ds_read_b64_tr_b16 a[26:27], v16 offset:27648
    buffer_load_dwordx4 v12, s[12:15], s53 offen lds
    v_rcp_f32 v28, v28
    v_mfma_f32_32x32x16_bf16 v[176:191], a[4:7], v[100:103], v[176:191]
    s_waitcnt vmcnt(13) lgkmcnt(8)
    ds_read_b64_tr_b16 a[40:41], v8 offset:2048
    ds_read_b64_tr_b16 a[42:43], v8 offset:3072
    ds_read_b64_tr_b16 a[28:29], v16 offset:30720
    ds_read_b64_tr_b16 a[30:31], v16 offset:31744
    v_rcp_f32 v29, v29
    v_mfma_f32_32x32x16_bf16 v[176:191], a[8:11], v[104:107], v[176:191]
    s_barrier
    ds_read_b64_tr_b16 a[0:1], v16 offset:34816
    ds_read_b64_tr_b16 a[2:3], v16 offset:35840
    buffer_load_dwordx4 v13, s[12:15], s53 offen offset:1024 lds
    v_mul_f32 v212, v28, v212
    v_mfma_f32_32x32x16_bf16 v[176:191], a[12:15], v[108:111], v[176:191]
    s_waitcnt lgkmcnt(8)
    ds_read_b64_tr_b16 a[44:45], v9 offset:2048
    ds_read_b64_tr_b16 a[46:47], v9 offset:3072
    ds_read_b64_tr_b16 a[4:5], v16 offset:38912
    ds_read_b64_tr_b16 a[6:7], v16 offset:39936
    v_mul_f32 v213, v29, v213
    v_mul_f32 v31, v20, v215
    v_mfma_f32_32x32x16_bf16 v[176:191], a[16:19], v[112:115], v[176:191]
    s_add_u32 m0, s43, 0
    ds_read_b64_tr_b16 a[8:9], v16 offset:43008
    ds_read_b64_tr_b16 a[10:11], v16 offset:44032
    buffer_load_dwordx4 v4, s[20:23], s64 offen lds
    v_exp_f32 v30, v30
    v_mfma_f32_32x32x16_bf16 v[176:191], a[20:23], v[116:119], v[176:191]
    s_waitcnt vmcnt(13) lgkmcnt(8)
    ds_read_b64_tr_b16 a[48:49], v8 offset:4096
    ds_read_b64_tr_b16 a[50:51], v8 offset:5120
    ds_read_b64_tr_b16 a[12:13], v16 offset:47104
    ds_read_b64_tr_b16 a[14:15], v16 offset:48128
    v_exp_f32 v31, v31
    v_mfma_f32_32x32x16_bf16 v[176:191], a[24:27], v[120:123], v[176:191]
    ds_read_b64_tr_b16 a[16:17], v15 offset:49152
    ds_read_b64_tr_b16 a[18:19], v15 offset:50176
    buffer_load_dwordx4 v5, s[20:23], s64 offen offset:1024 lds
    v_add_u32 v4, s65, v4
    v_add_u32 v5, s65, v5
    v_mfma_f32_32x32x16_bf16 v[176:191], a[28:31], v[124:127], v[176:191]
    s_waitcnt lgkmcnt(8)
    ds_read_b64_tr_b16 a[52:53], v9 offset:4096
    ds_read_b64_tr_b16 a[54:55], v9 offset:5120
    ds_read_b64_tr_b16 a[20:21], v15 offset:53248
    ds_read_b64_tr_b16 a[22:23], v15 offset:54272
    v_fma_f32 v30, v30, v21, v21
    v_fma_f32 v31, v31, v21, v21
    v_mfma_f32_32x32x16_bf16 v[176:191], a[0:3], v[128:131], v[176:191]
    s_add_u32 m0, s43, 2048
    ds_read_b64_tr_b16 a[24:25], v15 offset:57344
    ds_read_b64_tr_b16 a[26:27], v15 offset:58368
    buffer_load_dwordx4 v4, s[20:23], s58 offen lds
    v_rcp_f32 v30, v30
    v_mfma_f32_32x32x16_bf16 v[176:191], a[4:7], v[132:135], v[176:191]
    s_waitcnt vmcnt(13) lgkmcnt(8)
    ds_read_b64_tr_b16 a[56:57], v8 offset:6144
    ds_read_b64_tr_b16 a[58:59], v8 offset:7168
    ds_read_b64_tr_b16 a[28:29], v15 offset:61440
    ds_read_b64_tr_b16 a[30:31], v15 offset:62464
    v_rcp_f32 v31, v31
    v_mfma_f32_32x32x16_bf16 v[176:191], a[8:11], v[136:139], v[176:191]
    ds_read_b64_tr_b16 a[0:1], v17 offset:0
    ds_read_b64_tr_b16 a[2:3], v17 offset:1024
    buffer_load_dwordx4 v5, s[20:23], s58 offen offset:1024 lds
    v_mul_f32 v214, v30, v214
    v_mul_f32 v215, v31, v215
    v_mfma_f32_32x32x16_bf16 v[176:191], a[12:15], v[140:143], v[176:191]
    s_waitcnt lgkmcnt(8)
    ds_read_b64_tr_b16 a[60:61], v9 offset:6144
    ds_read_b64_tr_b16 a[62:63], v9 offset:7168
    ds_read_b64_tr_b16 a[4:5], v17 offset:4096
    ds_read_b64_tr_b16 a[6:7], v17 offset:5120
    v_mul_f32 v24, v20, v216
    v_mul_f32 v25, v20, v217
    v_mfma_f32_32x32x16_bf16 v[224:239], a[16:19], v[80:83], v[224:239]
    s_add_u32 m0, s43, 4096
    ds_read_b64_tr_b16 a[8:9], v17 offset:8192
    ds_read_b64_tr_b16 a[10:11], v17 offset:9216
    buffer_load_dwordx4 v4, s[20:23], s59 offen lds
    v_exp_f32 v24, v24
    v_mfma_f32_32x32x16_bf16 v[224:239], a[20:23], v[84:87], v[224:239]
    s_waitcnt lgkmcnt(8)
    ds_read_b64_tr_b16 a[12:13], v17 offset:12288
    ds_read_b64_tr_b16 a[14:15], v17 offset:13312
    v_exp_f32 v25, v25
    v_fma_f32 v24, v24, v21, v21
    v_fma_f32 v25, v25, v21, v21
    v_mfma_f32_32x32x16_bf16 v[224:239], a[24:27], v[88:91], v[224:239]
    ds_read_b64_tr_b16 a[16:17], v17 offset:16384
    ds_read_b64_tr_b16 a[18:19], v17 offset:17408
    buffer_load_dwordx4 v5, s[20:23], s59 offen offset:1024 lds
    v_rcp_f32 v24, v24
    v_mfma_f32_32x32x16_bf16 v[224:239], a[28:31], v[92:95], v[224:239]
    s_waitcnt lgkmcnt(6)
    ds_read_b64_tr_b16 a[20:21], v17 offset:20480
    ds_read_b64_tr_b16 a[22:23], v17 offset:21504
    v_rcp_f32 v25, v25
    v_mul_f32 v216, v24, v216
    v_mul_f32 v217, v25, v217
    v_mfma_f32_32x32x16_bf16 v[224:239], a[0:3], v[96:99], v[224:239]
    s_add_u32 m0, s43, 6144
    ds_read_b64_tr_b16 a[24:25], v17 offset:24576
    ds_read_b64_tr_b16 a[26:27], v17 offset:25600
    buffer_load_dwordx4 v4, s[20:23], s60 offen lds
    v_mul_f32 v26, v20, v218
    v_mul_f32 v27, v20, v219
    v_mfma_f32_32x32x16_bf16 v[224:239], a[4:7], v[100:103], v[224:239]
    s_waitcnt lgkmcnt(6)
    ds_read_b64_tr_b16 a[28:29], v17 offset:28672
    ds_read_b64_tr_b16 a[30:31], v17 offset:29696
    v_exp_f32 v26, v26
    v_exp_f32 v27, v27
    v_mfma_f32_32x32x16_bf16 v[224:239], a[8:11], v[104:107], v[224:239]
    ds_read_b64_tr_b16 a[0:1], v17 offset:32768
    ds_read_b64_tr_b16 a[2:3], v17 offset:33792
    buffer_load_dwordx4 v5, s[20:23], s60 offen offset:1024 lds
    v_fma_f32 v26, v26, v21, v21
    v_fma_f32 v27, v27, v21, v21
    v_mfma_f32_32x32x16_bf16 v[224:239], a[12:15], v[108:111], v[224:239]
    s_waitcnt lgkmcnt(6)
    ds_read_b64_tr_b16 a[4:5], v17 offset:36864
    ds_read_b64_tr_b16 a[6:7], v17 offset:37888
    v_rcp_f32 v26, v26
    v_rcp_f32 v27, v27
    v_mfma_f32_32x32x16_bf16 v[224:239], a[16:19], v[112:115], v[224:239]
    s_barrier
    s_add_u32 m0, s42, 49152
    ds_read_b64_tr_b16 a[8:9], v17 offset:40960
    ds_read_b64_tr_b16 a[10:11], v17 offset:41984
    buffer_load_dwordx4 v12, s[12:15], s54 offen lds
    v_mfma_f32_32x32x16_bf16 v[224:239], a[20:23], v[116:119], v[224:239]
    s_waitcnt lgkmcnt(6)
    ds_read_b64_tr_b16 a[12:13], v17 offset:45056
    ds_read_b64_tr_b16 a[14:15], v17 offset:46080
    v_mul_f32 v218, v26, v218
    v_mul_f32 v219, v27, v219
    v_mul_f32 v28, v20, v220
    v_mul_f32 v29, v20, v221
    v_mfma_f32_32x32x16_bf16 v[224:239], a[24:27], v[120:123], v[224:239]
    ds_read_b64_tr_b16 a[16:17], v15 offset:2048
    ds_read_b64_tr_b16 a[18:19], v15 offset:3072
    buffer_load_dwordx4 v13, s[12:15], s54 offen offset:1024 lds
    v_exp_f32 v28, v28
    v_mfma_f32_32x32x16_bf16 v[224:239], a[28:31], v[124:127], v[224:239]
    s_waitcnt lgkmcnt(6)
    ds_read_b64_tr_b16 a[20:21], v15 offset:6144
    ds_read_b64_tr_b16 a[22:23], v15 offset:7168
    v_exp_f32 v29, v29
    v_fma_f32 v28, v28, v21, v21
    v_fma_f32 v29, v29, v21, v21
    v_mfma_f32_32x32x16_bf16 v[224:239], a[0:3], v[128:131], v[224:239]
    s_add_u32 m0, s42, 65536
    ds_read_b64_tr_b16 a[24:25], v15 offset:10240
    ds_read_b64_tr_b16 a[26:27], v15 offset:11264
    buffer_load_dwordx4 v12, s[12:15], s55 offen lds
    v_rcp_f32 v28, v28
    v_mfma_f32_32x32x16_bf16 v[224:239], a[4:7], v[132:135], v[224:239]
    s_waitcnt lgkmcnt(6)
    ds_read_b64_tr_b16 a[28:29], v15 offset:14336
    ds_read_b64_tr_b16 a[30:31], v15 offset:15360
    v_rcp_f32 v29, v29
    v_mul_f32 v220, v28, v220
    v_mul_f32 v221, v29, v221
    v_mfma_f32_32x32x16_bf16 v[224:239], a[8:11], v[136:139], v[224:239]
    ds_read_b64_tr_b16 a[0:1], v15 offset:18432
    ds_read_b64_tr_b16 a[2:3], v15 offset:19456
    buffer_load_dwordx4 v13, s[12:15], s55 offen offset:1024 lds
    v_mul_f32 v30, v20, v222
    v_mul_f32 v31, v20, v223
    v_mfma_f32_32x32x16_bf16 v[224:239], a[12:15], v[140:143], v[224:239]
    s_waitcnt lgkmcnt(6)
    ds_read_b64_tr_b16 a[4:5], v15 offset:22528
    ds_read_b64_tr_b16 a[6:7], v15 offset:23552
    v_exp_f32 v30, v30
    v_exp_f32 v31, v31
    v_mfma_f32_32x32x16_bf16 v[192:207], a[16:19], v[32:35], 0
    s_barrier
    s_add_u32 m0, s42, 81920
    ds_read_b64_tr_b16 a[8:9], v15 offset:26624
    ds_read_b64_tr_b16 a[10:11], v15 offset:27648
    buffer_load_dwordx4 v12, s[12:15], s56 offen lds
    v_mfma_f32_32x32x16_bf16 v[192:207], a[20:23], v[36:39], v[192:207]
    s_waitcnt lgkmcnt(6)
    ds_read_b64_tr_b16 a[12:13], v15 offset:30720
    ds_read_b64_tr_b16 a[14:15], v15 offset:31744
    v_fma_f32 v30, v30, v21, v21
    v_fma_f32 v31, v31, v21, v21
    v_rcp_f32 v30, v30
    v_mfma_f32_32x32x16_bf16 v[192:207], a[24:27], v[40:43], v[192:207]
    ds_read_b64_tr_b16 a[16:17], v15 offset:34816
    ds_read_b64_tr_b16 a[18:19], v15 offset:35840
    buffer_load_dwordx4 v13, s[12:15], s56 offen offset:1024 lds
    v_rcp_f32 v31, v31
    v_mfma_f32_32x32x16_bf16 v[192:207], a[28:31], v[44:47], v[192:207]
    s_waitcnt lgkmcnt(6)
    ds_read_b64_tr_b16 a[20:21], v15 offset:38912
    ds_read_b64_tr_b16 a[22:23], v15 offset:39936
    v_mul_f32 v222, v30, v222
    v_mul_f32 v223, v31, v223
    v_mul_f32 v208, v208, v176
    v_mul_f32 v209, v209, v177
    v_mfma_f32_32x32x16_bf16 v[192:207], a[0:3], v[48:51], v[192:207]
    s_add_u32 m0, s42, 98304
    ds_read_b64_tr_b16 a[24:25], v15 offset:43008
    ds_read_b64_tr_b16 a[26:27], v15 offset:44032
    buffer_load_dwordx4 v12, s[12:15], s57 offen lds
    v_mul_f32 v210, v210, v178
    v_mul_f32 v211, v211, v179
    v_mfma_f32_32x32x16_bf16 v[192:207], a[4:7], v[52:55], v[192:207]
    s_waitcnt lgkmcnt(6)
    ds_read_b64_tr_b16 a[28:29], v15 offset:47104
    ds_read_b64_tr_b16 a[30:31], v15 offset:48128
    v_mul_f32 v212, v212, v180
    v_mul_f32 v213, v213, v181
    v_mul_f32 v214, v214, v182
    v_mul_f32 v215, v215, v183
    v_mfma_f32_32x32x16_bf16 v[192:207], a[8:11], v[56:59], v[192:207]
    ds_read_b64_tr_b16 a[0:1], v15 offset:51200
    ds_read_b64_tr_b16 a[2:3], v15 offset:52224
    buffer_load_dwordx4 v13, s[12:15], s57 offen offset:1024 lds
    v_mul_f32 v216, v216, v184
    v_mul_f32 v217, v217, v185
    v_mfma_f32_32x32x16_bf16 v[192:207], a[12:15], v[60:63], v[192:207]
    s_waitcnt lgkmcnt(6)
    ds_read_b64_tr_b16 a[4:5], v15 offset:55296
    ds_read_b64_tr_b16 a[6:7], v15 offset:56320
    v_mul_f32 v218, v218, v186
    v_mul_f32 v219, v219, v187
    v_mul_f32 v220, v220, v188
    v_mul_f32 v221, v221, v189
    v_mfma_f32_32x32x16_bf16 v[192:207], a[16:19], v[64:67], v[192:207]
    s_barrier
    s_add_u32 m0, s42, 2048
    ds_read_b64_tr_b16 a[8:9], v15 offset:59392
    ds_read_b64_tr_b16 a[10:11], v15 offset:60416
    buffer_load_dwordx4 v12, s[16:19], s51 offen lds
    v_mfma_f32_32x32x16_bf16 v[192:207], a[20:23], v[68:71], v[192:207]
    s_waitcnt lgkmcnt(6)
    ds_read_b64_tr_b16 a[12:13], v15 offset:63488
    ds_read_b64_tr_b16 a[14:15], v15 offset:64512
    v_mul_f32 v222, v222, v190
    v_mul_f32 v223, v223, v191
    v_cvt_pk_bf16_f32 v176, v208, v209
    v_cvt_pk_bf16_f32 v177, v210, v211
    v_mfma_f32_32x32x16_bf16 v[192:207], a[24:27], v[72:75], v[192:207]
    ds_read_b64_tr_b16 a[16:17], v17 offset:2048
    ds_read_b64_tr_b16 a[18:19], v17 offset:3072
    buffer_load_dwordx4 v13, s[16:19], s51 offen offset:1024 lds
    v_cvt_pk_bf16_f32 v178, v212, v213
    v_cvt_pk_bf16_f32 v179, v214, v215
    v_mfma_f32_32x32x16_bf16 v[192:207], a[28:31], v[76:79], v[192:207]
    s_waitcnt lgkmcnt(6)
    ds_read_b64_tr_b16 a[20:21], v17 offset:6144
    ds_read_b64_tr_b16 a[22:23], v17 offset:7168
    v_cvt_pk_bf16_f32 v180, v216, v217
    v_cvt_pk_bf16_f32 v181, v218, v219
    v_cvt_pk_bf16_f32 v182, v220, v221
    v_cvt_pk_bf16_f32 v183, v222, v223
    v_mul_f32 v24, v20, v224
    v_mfma_f32_32x32x16_bf16 v[192:207], a[0:3], v[80:83], v[192:207]
    s_add_u32 m0, s42, 18432
    ds_read_b64_tr_b16 a[24:25], v17 offset:10240
    ds_read_b64_tr_b16 a[26:27], v17 offset:11264
    buffer_load_dwordx4 v12, s[16:19], s52 offen lds
    v_mul_f32 v25, v20, v225
    v_exp_f32 v24, v24
    v_mfma_f32_32x32x16_bf16 v[192:207], a[4:7], v[84:87], v[192:207]
    s_waitcnt lgkmcnt(6)
    ds_read_b64_tr_b16 a[28:29], v17 offset:14336
    ds_read_b64_tr_b16 a[30:31], v17 offset:15360
    buffer_store_dwordx4 v[176:179], v7, s[24:27], 0 offen sc1
    v_exp_f32 v25, v25
    v_fma_f32 v24, v24, v21, v21
    v_mfma_f32_32x32x16_bf16 v[192:207], a[8:11], v[88:91], v[192:207]
    ds_read_b64_tr_b16 a[0:1], v17 offset:18432
    ds_read_b64_tr_b16 a[2:3], v17 offset:19456
    buffer_load_dwordx4 v13, s[16:19], s52 offen offset:1024 lds
    v_fma_f32 v25, v25, v21, v21
    v_rcp_f32 v24, v24
    v_mfma_f32_32x32x16_bf16 v[192:207], a[12:15], v[92:95], v[192:207]
    s_waitcnt lgkmcnt(6)
    ds_read_b64_tr_b16 a[4:5], v17 offset:22528
    ds_read_b64_tr_b16 a[6:7], v17 offset:23552
    buffer_store_dwordx4 v[180:183], v7, s[24:27], s69 offen sc1
    v_add_u32 v7, s67, v7
    v_rcp_f32 v25, v25
    v_mfma_f32_32x32x16_bf16 v[192:207], a[16:19], v[96:99], v[192:207]
    s_barrier
    s_add_u32 m0, s42, 34816
    ds_read_b64_tr_b16 a[8:9], v17 offset:26624
    ds_read_b64_tr_b16 a[10:11], v17 offset:27648
    buffer_load_dwordx4 v12, s[16:19], s53 offen lds
    v_mul_f32 v224, v24, v224
    v_mfma_f32_32x32x16_bf16 v[192:207], a[20:23], v[100:103], v[192:207]
    s_waitcnt lgkmcnt(6)
    ds_read_b64_tr_b16 a[12:13], v17 offset:30720
    ds_read_b64_tr_b16 a[14:15], v17 offset:31744
    v_mul_f32 v225, v25, v225
    v_mul_f32 v26, v20, v226
    v_mul_f32 v27, v20, v227
    v_exp_f32 v26, v26
    v_mfma_f32_32x32x16_bf16 v[192:207], a[24:27], v[104:107], v[192:207]
    ds_read_b64_tr_b16 a[16:17], v17 offset:34816
    ds_read_b64_tr_b16 a[18:19], v17 offset:35840
    buffer_load_dwordx4 v13, s[16:19], s53 offen offset:1024 lds
    v_exp_f32 v27, v27
    v_fma_f32 v26, v26, v21, v21
    v_mfma_f32_32x32x16_bf16 v[192:207], a[28:31], v[108:111], v[192:207]
    s_waitcnt lgkmcnt(6)
    ds_read_b64_tr_b16 a[20:21], v17 offset:38912
    ds_read_b64_tr_b16 a[22:23], v17 offset:39936
    v_fma_f32 v27, v27, v21, v21
    v_rcp_f32 v26, v26
    v_rcp_f32 v27, v27
    v_mfma_f32_32x32x16_bf16 v[192:207], a[0:3], v[112:115], v[192:207]
    s_add_u32 m0, s42, 51200
    ds_read_b64_tr_b16 a[24:25], v17 offset:43008
    ds_read_b64_tr_b16 a[26:27], v17 offset:44032
    buffer_load_dwordx4 v12, s[16:19], s54 offen lds
    v_mul_f32 v226, v26, v226
    v_mul_f32 v227, v27, v227
    v_mul_f32 v28, v20, v228
    v_mfma_f32_32x32x16_bf16 v[192:207], a[4:7], v[116:119], v[192:207]
    s_waitcnt lgkmcnt(6)
    ds_read_b64_tr_b16 a[28:29], v17 offset:47104
    ds_read_b64_tr_b16 a[30:31], v17 offset:48128
    v_mul_f32 v29, v20, v229
    v_exp_f32 v28, v28
    v_exp_f32 v29, v29
    v_mfma_f32_32x32x16_bf16 v[192:207], a[8:11], v[120:123], v[192:207]
    s_waitcnt vmcnt(27)
    s_barrier
    ds_read_b64_tr_b16 a[0:1], v14 offset:0
    ds_read_b64_tr_b16 a[2:3], v14 offset:1024
    buffer_load_dwordx4 v13, s[16:19], s54 offen offset:1024 lds
    v_fma_f32 v28, v28, v21, v21
    v_fma_f32 v29, v29, v21, v21
    v_mfma_f32_32x32x16_bf16 v[192:207], a[12:15], v[124:127], v[192:207]
    s_waitcnt lgkmcnt(6)
    ds_read_b64_tr_b16 a[4:5], v14 offset:4096
    ds_read_b64_tr_b16 a[6:7], v14 offset:5120
    v_rcp_f32 v28, v28
    v_rcp_f32 v29, v29
    v_mul_f32 v228, v28, v228
    v_mfma_f32_32x32x16_bf16 v[192:207], a[16:19], v[128:131], v[192:207]
    s_add_u32 m0, s42, 67584
    ds_read_b64_tr_b16 a[8:9], v14 offset:8192
    ds_read_b64_tr_b16 a[10:11], v14 offset:9216
    buffer_load_dwordx4 v12, s[16:19], s55 offen lds
    v_mul_f32 v229, v29, v229
    v_mul_f32 v30, v20, v230
    v_mul_f32 v31, v20, v231
    v_mfma_f32_32x32x16_bf16 v[192:207], a[20:23], v[132:135], v[192:207]
    s_waitcnt lgkmcnt(6)
    ds_read_b64_tr_b16 a[12:13], v14 offset:12288
    ds_read_b64_tr_b16 a[14:15], v14 offset:13312
    v_exp_f32 v30, v30
    v_exp_f32 v31, v31
    v_fma_f32 v30, v30, v21, v21
    v_mfma_f32_32x32x16_bf16 v[192:207], a[24:27], v[136:139], v[192:207]
    ds_read_b64_tr_b16 a[16:17], v14 offset:16384
    ds_read_b64_tr_b16 a[18:19], v14 offset:17408
    buffer_load_dwordx4 v13, s[16:19], s55 offen offset:1024 lds
    v_fma_f32 v31, v31, v21, v21
    v_rcp_f32 v30, v30
    v_mfma_f32_32x32x16_bf16 v[192:207], a[28:31], v[140:143], v[192:207]
    s_waitcnt lgkmcnt(6)
    ds_read_b64_tr_b16 a[20:21], v14 offset:20480
    ds_read_b64_tr_b16 a[22:23], v14 offset:21504
    v_rcp_f32 v31, v31
    v_mul_f32 v230, v30, v230
    v_mul_f32 v231, v31, v231
    v_mul_f32 v24, v20, v232
    v_mfma_f32_32x32x16_bf16 v[144:159], a[0:3], v[32:35], 0
    s_waitcnt vmcnt(12)
    s_barrier
    s_add_u32 m0, s42, 83968
    ds_read_b64_tr_b16 a[24:25], v14 offset:24576
    ds_read_b64_tr_b16 a[26:27], v14 offset:25600
    buffer_load_dwordx4 v12, s[16:19], s56 offen lds
    v_mul_f32 v25, v20, v233
    v_mfma_f32_32x32x16_bf16 v[144:159], a[4:7], v[36:39], v[144:159]
    s_waitcnt lgkmcnt(6)
    ds_read_b64_tr_b16 a[64:65], v8 offset:8192
    ds_read_b64_tr_b16 a[66:67], v8 offset:9216
    ds_read_b64_tr_b16 a[28:29], v14 offset:28672
    ds_read_b64_tr_b16 a[30:31], v14 offset:29696
    v_exp_f32 v24, v24
    v_mul_f32 v26, v20, v234
    v_mfma_f32_32x32x16_bf16 v[144:159], a[8:11], v[40:43], v[144:159]
    ds_read_b64_tr_b16 a[0:1], v14 offset:32768
    ds_read_b64_tr_b16 a[2:3], v14 offset:33792
    buffer_load_dwordx4 v13, s[16:19], s56 offen offset:1024 lds
    v_exp_f32 v25, v25
    v_fma_f32 v24, v24, v21, v21
    v_mfma_f32_32x32x16_bf16 v[144:159], a[12:15], v[44:47], v[144:159]
    s_waitcnt lgkmcnt(8)
    ds_read_b64_tr_b16 a[68:69], v9 offset:8192
    ds_read_b64_tr_b16 a[70:71], v9 offset:9216
    ds_read_b64_tr_b16 a[4:5], v14 offset:36864
    ds_read_b64_tr_b16 a[6:7], v14 offset:37888
    v_fma_f32 v25, v25, v21, v21
    v_rcp_f32 v24, v24
    v_mfma_f32_32x32x16_bf16 v[144:159], a[16:19], v[48:51], v[144:159]
    s_add_u32 m0, s42, 100352
    ds_read_b64_tr_b16 a[8:9], v14 offset:40960
    ds_read_b64_tr_b16 a[10:11], v14 offset:41984
    buffer_load_dwordx4 v12, s[16:19], s57 offen lds
    v_rcp_f32 v25, v25
    v_mul_f32 v232, v24, v232
    v_mfma_f32_32x32x16_bf16 v[144:159], a[20:23], v[52:55], v[144:159]
    s_waitcnt lgkmcnt(8)
    ds_read_b64_tr_b16 a[72:73], v8 offset:10240
    ds_read_b64_tr_b16 a[74:75], v8 offset:11264
    ds_read_b64_tr_b16 a[12:13], v14 offset:45056
    ds_read_b64_tr_b16 a[14:15], v14 offset:46080
    v_mul_f32 v233, v25, v233
    v_mul_f32 v27, v20, v235
    v_mul_f32 v28, v20, v236
    v_mfma_f32_32x32x16_bf16 v[144:159], a[24:27], v[56:59], v[144:159]
    ds_read_b64_tr_b16 a[16:17], v14 offset:49152
    ds_read_b64_tr_b16 a[18:19], v14 offset:50176
    buffer_load_dwordx4 v13, s[16:19], s57 offen offset:1024 lds
    v_exp_f32 v26, v26
    v_mul_f32 v29, v20, v237
    v_mfma_f32_32x32x16_bf16 v[144:159], a[28:31], v[60:63], v[144:159]
    s_waitcnt lgkmcnt(8)
    ds_read_b64_tr_b16 a[76:77], v9 offset:10240
    ds_read_b64_tr_b16 a[78:79], v9 offset:11264
    ds_read_b64_tr_b16 a[20:21], v14 offset:53248
    ds_read_b64_tr_b16 a[22:23], v14 offset:54272
    v_exp_f32 v27, v27
    v_fma_f32 v26, v26, v21, v21
    v_mfma_f32_32x32x16_bf16 v[144:159], a[0:3], v[64:67], v[144:159]
    s_add_u32 m0, s43, 8192
    ds_read_b64_tr_b16 a[24:25], v14 offset:57344
    ds_read_b64_tr_b16 a[26:27], v14 offset:58368
    buffer_load_dwordx4 v4, s[20:23], s61 offen lds
    v_fma_f32 v27, v27, v21, v21
    v_rcp_f32 v26, v26
    v_mfma_f32_32x32x16_bf16 v[144:159], a[4:7], v[68:71], v[144:159]
    s_waitcnt vmcnt(11) lgkmcnt(8)
    ds_read_b64_tr_b16 a[80:81], v8 offset:0
    ds_read_b64_tr_b16 a[82:83], v8 offset:1024
    ds_read_b64_tr_b16 a[28:29], v14 offset:61440
    ds_read_b64_tr_b16 a[30:31], v14 offset:62464
    buffer_store_byte v240, v241, s[24:27], s71 offen sc1
    v_mov_b32 v240, 12
    v_mfma_f32_32x32x16_bf16 v[144:159], a[8:11], v[72:75], v[144:159]
    ds_read_b64_tr_b16 a[0:1], v16 offset:0
    ds_read_b64_tr_b16 a[2:3], v16 offset:1024
    buffer_load_dwordx4 v5, s[20:23], s61 offen offset:1024 lds
    v_rcp_f32 v27, v27
    v_mul_f32 v234, v26, v234
    v_mfma_f32_32x32x16_bf16 v[144:159], a[12:15], v[76:79], v[144:159]
    s_waitcnt lgkmcnt(8)
    ds_read_b64_tr_b16 a[84:85], v9 offset:0
    ds_read_b64_tr_b16 a[86:87], v9 offset:1024
    ds_read_b64_tr_b16 a[4:5], v16 offset:4096
    ds_read_b64_tr_b16 a[6:7], v16 offset:5120
    v_mul_f32 v235, v27, v235
    v_exp_f32 v28, v28
    v_mfma_f32_32x32x16_bf16 v[144:159], a[16:19], v[80:83], v[144:159]
    s_add_u32 m0, s43, 10240
    ds_read_b64_tr_b16 a[8:9], v16 offset:8192
    ds_read_b64_tr_b16 a[10:11], v16 offset:9216
    buffer_load_dwordx4 v4, s[20:23], s62 offen lds
    v_exp_f32 v29, v29
    v_fma_f32 v28, v28, v21, v21
    v_mfma_f32_32x32x16_bf16 v[144:159], a[20:23], v[84:87], v[144:159]
    s_waitcnt lgkmcnt(8)
    ds_read_b64_tr_b16 a[88:89], v8 offset:2048
    ds_read_b64_tr_b16 a[90:91], v8 offset:3072
    ds_read_b64_tr_b16 a[12:13], v16 offset:12288
    ds_read_b64_tr_b16 a[14:15], v16 offset:13312
    v_fma_f32 v29, v29, v21, v21
    v_rcp_f32 v28, v28
    v_mfma_f32_32x32x16_bf16 v[144:159], a[24:27], v[88:91], v[144:159]
    ds_read_b64_tr_b16 a[16:17], v16 offset:16384
    ds_read_b64_tr_b16 a[18:19], v16 offset:17408
    buffer_load_dwordx4 v5, s[20:23], s62 offen offset:1024 lds
    v_rcp_f32 v29, v29
    v_mul_f32 v236, v28, v236
    v_mfma_f32_32x32x16_bf16 v[144:159], a[28:31], v[92:95], v[144:159]
    s_waitcnt lgkmcnt(8)
    ds_read_b64_tr_b16 a[92:93], v9 offset:2048
    ds_read_b64_tr_b16 a[94:95], v9 offset:3072
    ds_read_b64_tr_b16 a[20:21], v16 offset:20480
    ds_read_b64_tr_b16 a[22:23], v16 offset:21504
    v_mul_f32 v237, v29, v237
    v_mul_f32 v30, v20, v238
    v_mul_f32 v31, v20, v239
    v_mfma_f32_32x32x16_bf16 v[144:159], a[0:3], v[96:99], v[144:159]
    s_add_u32 m0, s43, 0
    ds_read_b64_tr_b16 a[24:25], v16 offset:24576
    ds_read_b64_tr_b16 a[26:27], v16 offset:25600
    buffer_load_dwordx4 v4, s[20:23], s63 offen lds
    v_exp_f32 v30, v30
    v_mfma_f32_32x32x16_bf16 v[144:159], a[4:7], v[100:103], v[144:159]
    s_waitcnt lgkmcnt(8)
    ds_read_b64_tr_b16 a[96:97], v8 offset:4096
    ds_read_b64_tr_b16 a[98:99], v8 offset:5120
    ds_read_b64_tr_b16 a[28:29], v16 offset:28672
    ds_read_b64_tr_b16 a[30:31], v16 offset:29696
    v_exp_f32 v31, v31
    v_fma_f32 v30, v30, v21, v21
    v_mfma_f32_32x32x16_bf16 v[144:159], a[8:11], v[104:107], v[144:159]
    ds_read_b64_tr_b16 a[0:1], v16 offset:32768
    ds_read_b64_tr_b16 a[2:3], v16 offset:33792
    buffer_load_dwordx4 v5, s[20:23], s63 offen offset:1024 lds
    v_fma_f32 v31, v31, v21, v21
    v_rcp_f32 v30, v30
    v_mfma_f32_32x32x16_bf16 v[144:159], a[12:15], v[108:111], v[144:159]
    s_waitcnt lgkmcnt(8)
    ds_read_b64_tr_b16 a[100:101], v9 offset:4096
    ds_read_b64_tr_b16 a[102:103], v9 offset:5120
    ds_read_b64_tr_b16 a[4:5], v16 offset:36864
    ds_read_b64_tr_b16 a[6:7], v16 offset:37888
    v_rcp_f32 v31, v31
    v_mul_f32 v238, v30, v238
    v_mfma_f32_32x32x16_bf16 v[144:159], a[16:19], v[112:115], v[144:159]
    s_add_u32 m0, s43, 2048
    ds_read_b64_tr_b16 a[8:9], v16 offset:40960
    ds_read_b64_tr_b16 a[10:11], v16 offset:41984
    buffer_load_dwordx4 v4, s[20:23], s64 offen lds
    v_mul_f32 v239, v31, v239
    v_mul_f32 v224, v224, v192
    v_mul_f32 v225, v225, v193
    v_mfma_f32_32x32x16_bf16 v[144:159], a[20:23], v[116:119], v[144:159]
    s_waitcnt lgkmcnt(8)
    ds_read_b64_tr_b16 a[104:105], v8 offset:6144
    ds_read_b64_tr_b16 a[106:107], v8 offset:7168
    ds_read_b64_tr_b16 a[12:13], v16 offset:45056
    ds_read_b64_tr_b16 a[14:15], v16 offset:46080
    v_mul_f32 v226, v226, v194
    v_mul_f32 v227, v227, v195
    v_mul_f32 v228, v228, v196
    v_mfma_f32_32x32x16_bf16 v[144:159], a[24:27], v[120:123], v[144:159]
    s_waitcnt vmcnt(16)
    s_barrier
    ds_read_b64_tr_b16 a[16:17], v14 offset:2048
    ds_read_b64_tr_b16 a[18:19], v14 offset:3072
    buffer_load_dwordx4 v5, s[20:23], s64 offen offset:1024 lds
    v_add_u32 v4, s66, v4
    v_add_u32 v5, s66, v5
    v_mfma_f32_32x32x16_bf16 v[144:159], a[28:31], v[124:127], v[144:159]
    s_waitcnt lgkmcnt(8)
    ds_read_b64_tr_b16 a[108:109], v9 offset:6144
    ds_read_b64_tr_b16 a[110:111], v9 offset:7168
    ds_read_b64_tr_b16 a[20:21], v14 offset:6144
    ds_read_b64_tr_b16 a[22:23], v14 offset:7168
    v_mul_f32 v229, v229, v197
    v_mul_f32 v230, v230, v198
    v_mul_f32 v231, v231, v199
    v_mfma_f32_32x32x16_bf16 v[144:159], a[0:3], v[128:131], v[144:159]
    s_add_u32 m0, s43, 4096
    ds_read_b64_tr_b16 a[24:25], v14 offset:10240
    ds_read_b64_tr_b16 a[26:27], v14 offset:11264
    buffer_load_dwordx4 v4, s[20:23], s58 offen lds
    v_mul_f32 v232, v232, v200
    v_mul_f32 v233, v233, v201
    v_mul_f32 v234, v234, v202
    v_mfma_f32_32x32x16_bf16 v[144:159], a[4:7], v[132:135], v[144:159]
    s_waitcnt lgkmcnt(8)
    ds_read_b64_tr_b16 a[28:29], v14 offset:14336
    ds_read_b64_tr_b16 a[30:31], v14 offset:15360
    v_mul_f32 v235, v235, v203
    v_mul_f32 v236, v236, v204
    v_mul_f32 v237, v237, v205
    v_mul_f32 v238, v238, v206
    v_mul_f32 v239, v239, v207
    v_mfma_f32_32x32x16_bf16 v[144:159], a[8:11], v[136:139], v[144:159]
    ds_read_b64_tr_b16 a[0:1], v14 offset:18432
    ds_read_b64_tr_b16 a[2:3], v14 offset:19456
    buffer_load_dwordx4 v5, s[20:23], s58 offen offset:1024 lds
    v_cvt_pk_bf16_f32 v192, v224, v225
    v_cvt_pk_bf16_f32 v193, v226, v227
    v_cvt_pk_bf16_f32 v194, v228, v229
    v_mfma_f32_32x32x16_bf16 v[144:159], a[12:15], v[140:143], v[144:159]
    s_waitcnt lgkmcnt(6)
    ds_read_b64_tr_b16 a[4:5], v14 offset:22528
    ds_read_b64_tr_b16 a[6:7], v14 offset:23552
    v_cvt_pk_bf16_f32 v195, v230, v231
    v_cvt_pk_bf16_f32 v196, v232, v233
    v_cvt_pk_bf16_f32 v197, v234, v235
    v_cvt_pk_bf16_f32 v198, v236, v237
    v_cvt_pk_bf16_f32 v199, v238, v239
    v_mfma_f32_32x32x16_bf16 v[160:175], a[16:19], v[32:35], 0
    s_add_u32 m0, s43, 6144
    ds_read_b64_tr_b16 a[8:9], v14 offset:26624
    ds_read_b64_tr_b16 a[10:11], v14 offset:27648
    buffer_load_dwordx4 v4, s[20:23], s59 offen lds
    v_mfma_f32_32x32x16_bf16 v[160:175], a[20:23], v[36:39], v[160:175]
    s_waitcnt lgkmcnt(6)
    ds_read_b64_tr_b16 a[12:13], v14 offset:30720
    ds_read_b64_tr_b16 a[14:15], v14 offset:31744
    buffer_store_dwordx4 v[192:195], v7, s[24:27], 0 offen sc1
    v_mfma_f32_32x32x16_bf16 v[160:175], a[24:27], v[40:43], v[160:175]
    ds_read_b64_tr_b16 a[16:17], v14 offset:34816
    ds_read_b64_tr_b16 a[18:19], v14 offset:35840
    buffer_load_dwordx4 v5, s[20:23], s59 offen offset:1024 lds
    v_mul_f32 v24, v20, v144
    v_mul_f32 v25, v20, v145
    v_mul_f32 v26, v20, v146
    v_mfma_f32_32x32x16_bf16 v[160:175], a[28:31], v[44:47], v[160:175]
    s_waitcnt lgkmcnt(6)
    ds_read_b64_tr_b16 a[20:21], v14 offset:38912
    ds_read_b64_tr_b16 a[22:23], v14 offset:39936
    buffer_store_dwordx4 v[196:199], v7, s[24:27], s69 offen sc1
    v_add_u32 v7, s68, v7
    v_exp_f32 v24, v24
    v_mfma_f32_32x32x16_bf16 v[160:175], a[0:3], v[48:51], v[160:175]
    ds_read_b64_tr_b16 a[24:25], v14 offset:43008
    ds_read_b64_tr_b16 a[26:27], v14 offset:44032
    v_exp_f32 v25, v25
    v_fma_f32 v24, v24, v21, v21
    v_fma_f32 v25, v25, v21, v21
    v_mul_f32 v27, v20, v147
    v_mfma_f32_32x32x16_bf16 v[160:175], a[4:7], v[52:55], v[160:175]
    s_waitcnt lgkmcnt(6)
    ds_read_b64_tr_b16 a[28:29], v14 offset:47104
    ds_read_b64_tr_b16 a[30:31], v14 offset:48128
    v_rcp_f32 v24, v24
    v_rcp_f32 v25, v25
    v_mul_f32 v144, v24, v144
    v_mfma_f32_32x32x16_bf16 v[160:175], a[8:11], v[56:59], v[160:175]
    s_waitcnt vmcnt(15)
    s_barrier
    ds_read_b64_tr_b16 a[0:1], v14 offset:51200
    ds_read_b64_tr_b16 a[2:3], v14 offset:52224
    v_mul_f32 v145, v25, v145
    v_exp_f32 v26, v26
    v_mul_f32 v28, v20, v148
    v_mfma_f32_32x32x16_bf16 v[160:175], a[12:15], v[60:63], v[160:175]
    s_waitcnt lgkmcnt(6)
    ds_read_b64_tr_b16 a[4:5], v14 offset:55296
    ds_read_b64_tr_b16 a[6:7], v14 offset:56320
    v_exp_f32 v27, v27
    v_fma_f32 v26, v26, v21, v21
    v_fma_f32 v27, v27, v21, v21
    v_mul_f32 v29, v20, v149
    v_mfma_f32_32x32x16_bf16 v[160:175], a[16:19], v[64:67], v[160:175]
    ds_read_b64_tr_b16 a[8:9], v14 offset:59392
    ds_read_b64_tr_b16 a[10:11], v14 offset:60416
    v_rcp_f32 v26, v26
    v_rcp_f32 v27, v27
    v_mul_f32 v146, v26, v146
    v_mfma_f32_32x32x16_bf16 v[160:175], a[20:23], v[68:71], v[160:175]
    s_waitcnt vmcnt(12) lgkmcnt(6)
    s_load_dwordx4 s[44:47], s[24:25], s48 glc
    ds_read_b64_tr_b16 a[112:113], v8 offset:8192
    ds_read_b64_tr_b16 a[114:115], v8 offset:9216
    ds_read_b64_tr_b16 a[12:13], v14 offset:63488
    ds_read_b64_tr_b16 a[14:15], v14 offset:64512
    v_mul_f32 v147, v27, v147
    v_mul_f32 v30, v20, v150
    v_mfma_f32_32x32x16_bf16 v[160:175], a[24:27], v[72:75], v[160:175]
    ds_read_b64_tr_b16 a[16:17], v16 offset:2048
    ds_read_b64_tr_b16 a[18:19], v16 offset:3072
    v_exp_f32 v28, v28
    v_exp_f32 v29, v29
    v_fma_f32 v28, v28, v21, v21
    v_mfma_f32_32x32x16_bf16 v[160:175], a[28:31], v[76:79], v[160:175]
    s_waitcnt lgkmcnt(8)
    ds_read_b64_tr_b16 a[116:117], v9 offset:8192
    ds_read_b64_tr_b16 a[118:119], v9 offset:9216
    ds_read_b64_tr_b16 a[20:21], v16 offset:6144
    ds_read_b64_tr_b16 a[22:23], v16 offset:7168
    v_fma_f32 v29, v29, v21, v21
    v_rcp_f32 v28, v28
    v_mfma_f32_32x32x16_bf16 v[160:175], a[0:3], v[80:83], v[160:175]
    ds_read_b64_tr_b16 a[24:25], v16 offset:10240
    ds_read_b64_tr_b16 a[26:27], v16 offset:11264
    v_rcp_f32 v29, v29
    v_mul_f32 v148, v28, v148
    v_mul_f32 v149, v29, v149
    v_mul_f32 v31, v20, v151
    v_mfma_f32_32x32x16_bf16 v[160:175], a[4:7], v[84:87], v[160:175]
    s_waitcnt vmcnt(10) lgkmcnt(8)
    ds_read_b64_tr_b16 a[120:121], v8 offset:10240
    ds_read_b64_tr_b16 a[122:123], v8 offset:11264
    ds_read_b64_tr_b16 a[28:29], v16 offset:14336
    ds_read_b64_tr_b16 a[30:31], v16 offset:15360
    v_exp_f32 v30, v30
    v_mul_f32 v24, v20, v152
    v_mfma_f32_32x32x16_bf16 v[160:175], a[8:11], v[88:91], v[160:175]
    ds_read_b64_tr_b16 a[0:1], v16 offset:18432
    ds_read_b64_tr_b16 a[2:3], v16 offset:19456
    v_exp_f32 v31, v31
    v_fma_f32 v30, v30, v21, v21
    v_fma_f32 v31, v31, v21, v21
    v_mul_f32 v25, v20, v153
    v_mfma_f32_32x32x16_bf16 v[160:175], a[12:15], v[92:95], v[160:175]
    s_waitcnt lgkmcnt(8)
    ds_read_b64_tr_b16 a[124:125], v9 offset:10240
    ds_read_b64_tr_b16 a[126:127], v9 offset:11264
    ds_read_b64_tr_b16 a[4:5], v16 offset:22528
    ds_read_b64_tr_b16 a[6:7], v16 offset:23552
    v_rcp_f32 v30, v30
    v_mul_f32 v26, v20, v154
    v_mfma_f32_32x32x16_bf16 v[160:175], a[16:19], v[96:99], v[160:175]
    s_add_u32 m0, s43, 8192
    ds_read_b64_tr_b16 a[8:9], v16 offset:26624
    ds_read_b64_tr_b16 a[10:11], v16 offset:27648
    buffer_load_dwordx4 v4, s[20:23], s60 offen lds
    v_rcp_f32 v31, v31
    v_mul_f32 v150, v30, v150
    v_mfma_f32_32x32x16_bf16 v[160:175], a[20:23], v[100:103], v[160:175]
    s_waitcnt vmcnt(9) lgkmcnt(8)
    ds_read_b64_tr_b16 a[128:129], v8 offset:0
    ds_read_b64_tr_b16 a[130:131], v8 offset:1024
    ds_read_b64_tr_b16 a[12:13], v16 offset:30720
    ds_read_b64_tr_b16 a[14:15], v16 offset:31744
    v_mul_f32 v151, v31, v151
    v_exp_f32 v24, v24
    v_mfma_f32_32x32x16_bf16 v[160:175], a[24:27], v[104:107], v[160:175]
    ds_read_b64_tr_b16 a[16:17], v16 offset:34816
    ds_read_b64_tr_b16 a[18:19], v16 offset:35840
    buffer_load_dwordx4 v5, s[20:23], s60 offen offset:1024 lds
    v_exp_f32 v25, v25
    v_fma_f32 v24, v24, v21, v21
    v_mfma_f32_32x32x16_bf16 v[160:175], a[28:31], v[108:111], v[160:175]
    s_waitcnt lgkmcnt(8)
    ds_read_b64_tr_b16 a[132:133], v9 offset:0
    ds_read_b64_tr_b16 a[134:135], v9 offset:1024
    ds_read_b64_tr_b16 a[20:21], v16 offset:38912
    ds_read_b64_tr_b16 a[22:23], v16 offset:39936
    v_fma_f32 v25, v25, v21, v21
    v_rcp_f32 v24, v24
    v_mfma_f32_32x32x16_bf16 v[160:175], a[0:3], v[112:115], v[160:175]
    s_add_u32 m0, s43, 10240
    ds_read_b64_tr_b16 a[24:25], v16 offset:43008
    ds_read_b64_tr_b16 a[26:27], v16 offset:44032
    buffer_load_dwordx4 v4, s[20:23], s61 offen lds
    v_rcp_f32 v25, v25
    v_mul_f32 v152, v24, v152
    v_mfma_f32_32x32x16_bf16 v[160:175], a[4:7], v[116:119], v[160:175]
    s_waitcnt lgkmcnt(8)
    ds_read_b64_tr_b16 a[28:29], v16 offset:47104
    ds_read_b64_tr_b16 a[30:31], v16 offset:48128
    v_mul_f32 v153, v25, v153
    v_mul_f32 v27, v20, v155
    v_exp_f32 v26, v26
    v_mul_f32 v28, v20, v156
    v_mfma_f32_32x32x16_bf16 v[160:175], a[8:11], v[120:123], v[160:175]
    ds_read_b64_tr_b16 a[0:1], v15 offset:0
    ds_read_b64_tr_b16 a[2:3], v15 offset:1024
    buffer_load_dwordx4 v5, s[20:23], s61 offen offset:1024 lds
    v_exp_f32 v27, v27
    v_fma_f32 v26, v26, v21, v21
    v_mfma_f32_32x32x16_bf16 v[160:175], a[12:15], v[124:127], v[160:175]
    s_waitcnt lgkmcnt(0)
    s_or_b64 s[44:45], s[44:45], s[46:47]
    s_or_b32 s44, s44, s45
    s_and_b32 s44, s44, 16843009
    s_cbranch_scc1 L_slow0
L_back0:
    ds_read_b64_tr_b16 a[4:5], v15 offset:4096
    ds_read_b64_tr_b16 a[6:7], v15 offset:5120
    v_fma_f32 v27, v27, v21, v21
    v_mfma_f32_32x32x16_bf16 v[160:175], a[16:19], v[128:131], v[160:175]
    s_add_u32 m0, s43, 0
    ds_read_b64_tr_b16 a[8:9], v15 offset:8192
    ds_read_b64_tr_b16 a[10:11], v15 offset:9216
    buffer_load_dwordx4 v4, s[20:23], s62 offen lds
    v_rcp_f32 v26, v26
    v_mul_f32 v29, v20, v157
    v_mfma_f32_32x32x16_bf16 v[160:175], a[20:23], v[132:135], v[160:175]
    s_waitcnt vmcnt(5)
    ds_read_b64_tr_b16 a[12:13], v15 offset:12288
    ds_read_b64_tr_b16 a[14:15], v15 offset:13312
    buffer_store_byte v240, v241, s[24:27], s71 offen sc1
    v_mov_b32 v240, 8
    v_rcp_f32 v27, v27
    v_mfma_f32_32x32x16_bf16 v[160:175], a[24:27], v[136:139], v[160:175]
    ds_read_b64_tr_b16 a[16:17], v15 offset:16384
    ds_read_b64_tr_b16 a[18:19], v15 offset:17408
    buffer_load_dwordx4 v5, s[20:23], s62 offen offset:1024 lds
    v_mul_f32 v154, v26, v154
    v_mul_f32 v155, v27, v155
    v_mul_f32 v30, v20, v158
    v_mfma_f32_32x32x16_bf16 v[160:175], a[28:31], v[140:143], v[160:175]
    s_waitcnt lgkmcnt(6)
    ds_read_b64_tr_b16 a[20:21], v15 offset:20480
    ds_read_b64_tr_b16 a[22:23], v15 offset:21504
    v_exp_f32 v28, v28
    v_exp_f32 v29, v29
    v_fma_f32 v28, v28, v21, v21
    v_mfma_f32_32x32x16_bf16 v[176:191], a[0:3], v[32:35], 0
    ds_read_b64_tr_b16 a[24:25], v15 offset:24576
    ds_read_b64_tr_b16 a[26:27], v15 offset:25600
    buffer_load_dwordx4 a[144:147], v6, s[24:27], s58 offen offset:0 sc1
    v_fma_f32 v29, v29, v21, v21
    v_rcp_f32 v28, v28
    v_mfma_f32_32x32x16_bf16 v[176:191], a[4:7], v[36:39], v[176:191]
    s_waitcnt lgkmcnt(6)
    ds_read_b64_tr_b16 a[28:29], v15 offset:28672
    ds_read_b64_tr_b16 a[30:31], v15 offset:29696
    v_rcp_f32 v29, v29
    v_mul_f32 v156, v28, v156
    v_mul_f32 v157, v29, v157
    v_mul_f32 v31, v20, v159
    v_mfma_f32_32x32x16_bf16 v[176:191], a[8:11], v[40:43], v[176:191]
    ds_read_b64_tr_b16 a[0:1], v15 offset:32768
    ds_read_b64_tr_b16 a[2:3], v15 offset:33792
    buffer_load_dwordx4 a[148:151], v6, s[24:27], s58 offen offset:1024 sc1
    v_exp_f32 v30, v30
    v_mfma_f32_32x32x16_bf16 v[176:191], a[12:15], v[44:47], v[176:191]
    s_waitcnt lgkmcnt(6)
    ds_read_b64_tr_b16 a[4:5], v15 offset:36864
    ds_read_b64_tr_b16 a[6:7], v15 offset:37888
    v_exp_f32 v31, v31
    v_fma_f32 v30, v30, v21, v21
    v_fma_f32 v31, v31, v21, v21
    v_mfma_f32_32x32x16_bf16 v[176:191], a[16:19], v[48:51], v[176:191]
    ds_read_b64_tr_b16 a[8:9], v15 offset:40960
    ds_read_b64_tr_b16 a[10:11], v15 offset:41984
    buffer_load_dwordx4 a[152:155], v6, s[24:27], s59 offen offset:0 sc1
    v_rcp_f32 v30, v30
    v_mfma_f32_32x32x16_bf16 v[176:191], a[20:23], v[52:55], v[176:191]
    s_waitcnt lgkmcnt(6)
    ds_read_b64_tr_b16 a[12:13], v15 offset:45056
    ds_read_b64_tr_b16 a[14:15], v15 offset:46080
    v_rcp_f32 v31, v31
    v_mul_f32 v158, v30, v158
    v_mul_f32 v159, v31, v159
    v_mul_f32 v144, v144, v160
    v_mfma_f32_32x32x16_bf16 v[176:191], a[24:27], v[56:59], v[176:191]
    ds_read_b64_tr_b16 a[16:17], v15 offset:49152
    ds_read_b64_tr_b16 a[18:19], v15 offset:50176
    buffer_load_dwordx4 a[156:159], v6, s[24:27], s59 offen offset:1024 sc1
    v_mul_f32 v145, v145, v161
    v_mul_f32 v146, v146, v162
    v_mul_f32 v147, v147, v163
    v_mfma_f32_32x32x16_bf16 v[176:191], a[28:31], v[60:63], v[176:191]
    s_waitcnt lgkmcnt(6)
    ds_read_b64_tr_b16 a[20:21], v15 offset:53248
    ds_read_b64_tr_b16 a[22:23], v15 offset:54272
    v_mul_f32 v148, v148, v164
    v_mul_f32 v149, v149, v165
    v_mul_f32 v150, v150, v166
    v_mul_f32 v151, v151, v167
    v_mul_f32 v152, v152, v168
    v_mfma_f32_32x32x16_bf16 v[176:191], a[0:3], v[64:67], v[176:191]
    ds_read_b64_tr_b16 a[24:25], v15 offset:57344
    ds_read_b64_tr_b16 a[26:27], v15 offset:58368
    buffer_load_dwordx4 a[160:163], v6, s[24:27], s60 offen offset:0 sc1
    v_mul_f32 v153, v153, v169
    v_mul_f32 v154, v154, v170
    v_mul_f32 v155, v155, v171
    v_mfma_f32_32x32x16_bf16 v[176:191], a[4:7], v[68:71], v[176:191]
    s_waitcnt lgkmcnt(6)
    ds_read_b64_tr_b16 a[28:29], v15 offset:61440
    ds_read_b64_tr_b16 a[30:31], v15 offset:62464
    v_mul_f32 v156, v156, v172
    v_mul_f32 v157, v157, v173
    v_mul_f32 v158, v158, v174
    v_mul_f32 v159, v159, v175
    v_cvt_pk_bf16_f32 v160, v144, v145
    v_mfma_f32_32x32x16_bf16 v[176:191], a[8:11], v[72:75], v[176:191]
    ds_read_b64_tr_b16 a[0:1], v17 offset:0
    ds_read_b64_tr_b16 a[2:3], v17 offset:1024
    buffer_load_dwordx4 a[164:167], v6, s[24:27], s60 offen offset:1024 sc1
    v_cvt_pk_bf16_f32 v161, v146, v147
    v_cvt_pk_bf16_f32 v162, v148, v149
    v_cvt_pk_bf16_f32 v163, v150, v151
    v_mfma_f32_32x32x16_bf16 v[176:191], a[12:15], v[76:79], v[176:191]
    s_waitcnt lgkmcnt(6)
    ds_read_b64_tr_b16 a[4:5], v17 offset:4096
    ds_read_b64_tr_b16 a[6:7], v17 offset:5120
    v_cvt_pk_bf16_f32 v164, v152, v153
    v_cvt_pk_bf16_f32 v165, v154, v155
    v_cvt_pk_bf16_f32 v166, v156, v157
    v_cvt_pk_bf16_f32 v167, v158, v159
    v_mfma_f32_32x32x16_bf16 v[176:191], a[16:19], v[80:83], v[176:191]
    ds_read_b64_tr_b16 a[8:9], v17 offset:8192
    ds_read_b64_tr_b16 a[10:11], v17 offset:9216
    buffer_load_dwordx4 a[168:171], v6, s[24:27], s61 offen offset:0 sc1
    v_mfma_f32_32x32x16_bf16 v[176:191], a[20:23], v[84:87], v[176:191]
    s_waitcnt lgkmcnt(6)
    ds_read_b64_tr_b16 a[12:13], v17 offset:12288
    ds_read_b64_tr_b16 a[14:15], v17 offset:13312
    buffer_store_dwordx4 v[160:163], v7, s[24:27], 0 offen sc1
    v_mfma_f32_32x32x16_bf16 v[176:191], a[24:27], v[88:91], v[176:191]
    ds_read_b64_tr_b16 a[16:17], v17 offset:16384
    ds_read_b64_tr_b16 a[18:19], v17 offset:17408
    buffer_load_dwordx4 a[172:175], v6, s[24:27], s61 offen offset:1024 sc1
    v_mfma_f32_32x32x16_bf16 v[176:191], a[28:31], v[92:95], v[176:191]
    s_waitcnt lgkmcnt(6)
    ds_read_b64_tr_b16 a[20:21], v17 offset:20480
    ds_read_b64_tr_b16 a[22:23], v17 offset:21504
    buffer_store_dwordx4 v[164:167], v7, s[24:27], s69 offen sc1
    v_add_u32 v7, s67, v7
    v_mfma_f32_32x32x16_bf16 v[176:191], a[0:3], v[96:99], v[176:191]
    ds_read_b64_tr_b16 a[24:25], v17 offset:24576
    ds_read_b64_tr_b16 a[26:27], v17 offset:25600
    buffer_load_dwordx4 a[176:179], v6, s[24:27], s62 offen offset:0 sc1
    v_mfma_f32_32x32x16_bf16 v[176:191], a[4:7], v[100:103], v[176:191]
    s_waitcnt lgkmcnt(6)
    ds_read_b64_tr_b16 a[28:29], v17 offset:28672
    ds_read_b64_tr_b16 a[30:31], v17 offset:29696
    v_mfma_f32_32x32x16_bf16 v[176:191], a[8:11], v[104:107], v[176:191]
    ds_read_b64_tr_b16 a[0:1], v17 offset:32768
    ds_read_b64_tr_b16 a[2:3], v17 offset:33792
    buffer_load_dwordx4 a[180:183], v6, s[24:27], s62 offen offset:1024 sc1
    v_mfma_f32_32x32x16_bf16 v[176:191], a[12:15], v[108:111], v[176:191]
    s_waitcnt lgkmcnt(6)
    ds_read_b64_tr_b16 a[4:5], v17 offset:36864
    ds_read_b64_tr_b16 a[6:7], v17 offset:37888
    v_mfma_f32_32x32x16_bf16 v[176:191], a[16:19], v[112:115], v[176:191]
    ds_read_b64_tr_b16 a[8:9], v17 offset:40960
    ds_read_b64_tr_b16 a[10:11], v17 offset:41984
    buffer_load_dwordx4 a[184:187], v6, s[24:27], s63 offen offset:0 sc1
    v_mfma_f32_32x32x16_bf16 v[176:191], a[20:23], v[116:119], v[176:191]
    s_waitcnt lgkmcnt(6)
    s_load_dwordx4 s[44:47], s[24:25], s48 glc
    ds_read_b64_tr_b16 a[136:137], v8 offset:2048
    ds_read_b64_tr_b16 a[138:139], v8 offset:3072
    ds_read_b64_tr_b16 a[12:13], v17 offset:45056
    ds_read_b64_tr_b16 a[14:15], v17 offset:46080
    v_mfma_f32_32x32x16_bf16 v[176:191], a[24:27], v[120:123], v[176:191]
    ds_read_b64_tr_b16 a[16:17], v15 offset:2048
    ds_read_b64_tr_b16 a[18:19], v15 offset:3072
    buffer_load_dwordx4 a[188:191], v6, s[24:27], s63 offen offset:1024 sc1
    v_mfma_f32_32x32x16_bf16 v[176:191], a[28:31], v[124:127], v[176:191]
    s_waitcnt lgkmcnt(8)
    ds_read_b64_tr_b16 a[140:141], v9 offset:2048
    ds_read_b64_tr_b16 a[142:143], v9 offset:3072
    ds_read_b64_tr_b16 a[20:21], v15 offset:6144
    ds_read_b64_tr_b16 a[22:23], v15 offset:7168
    v_mfma_f32_32x32x16_bf16 v[176:191], a[0:3], v[128:131], v[176:191]
    ds_read_b64_tr_b16 a[24:25], v15 offset:10240
    ds_read_b64_tr_b16 a[26:27], v15 offset:11264
    buffer_load_dwordx4 a[192:195], v6, s[24:27], s64 offen offset:0 sc1
    v_mfma_f32_32x32x16_bf16 v[176:191], a[4:7], v[132:135], v[176:191]
    s_waitcnt lgkmcnt(8)
    ds_read_b64_tr_b16 a[28:29], v15 offset:14336
    ds_read_b64_tr_b16 a[30:31], v15 offset:15360
    v_mfma_f32_32x32x16_bf16 v[176:191], a[8:11], v[136:139], v[176:191]
    ds_read_b64_tr_b16 a[0:1], v15 offset:18432
    ds_read_b64_tr_b16 a[2:3], v15 offset:19456
    buffer_load_dwordx4 a[196:199], v6, s[24:27], s64 offen offset:1024 sc1
    v_add_u32 v6, s67, v6
    v_mfma_f32_32x32x16_bf16 v[176:191], a[12:15], v[140:143], v[176:191]
    s_waitcnt lgkmcnt(6)
    ds_read_b64_tr_b16 a[4:5], v15 offset:22528
    ds_read_b64_tr_b16 a[6:7], v15 offset:23552
    v_mfma_f32_32x32x16_bf16 v[192:207], a[16:19], v[32:35], 0
    s_add_u32 m0, s43, 2048
    ds_read_b64_tr_b16 a[8:9], v15 offset:26624
    ds_read_b64_tr_b16 a[10:11], v15 offset:27648
    buffer_load_dwordx4 v4, s[20:23], s63 offen lds
    v_mfma_f32_32x32x16_bf16 v[192:207], a[20:23], v[36:39], v[192:207]
    s_waitcnt lgkmcnt(6)
    ds_read_b64_tr_b16 a[12:13], v15 offset:30720
    ds_read_b64_tr_b16 a[14:15], v15 offset:31744
    v_mfma_f32_32x32x16_bf16 v[192:207], a[24:27], v[40:43], v[192:207]
    ds_read_b64_tr_b16 a[16:17], v15 offset:34816
    ds_read_b64_tr_b16 a[18:19], v15 offset:35840
    buffer_load_dwordx4 v5, s[20:23], s63 offen offset:1024 lds
    v_mul_f32 v24, v20, v176
    v_mul_f32 v25, v20, v177
    v_mul_f32 v26, v20, v178
    v_mfma_f32_32x32x16_bf16 v[192:207], a[28:31], v[44:47], v[192:207]
    s_waitcnt lgkmcnt(6)
    ds_read_b64_tr_b16 a[20:21], v15 offset:38912
    ds_read_b64_tr_b16 a[22:23], v15 offset:39936
    v_exp_f32 v24, v24
    v_exp_f32 v25, v25
    v_fma_f32 v24, v24, v21, v21
    v_mfma_f32_32x32x16_bf16 v[192:207], a[0:3], v[48:51], v[192:207]
    ds_read_b64_tr_b16 a[24:25], v15 offset:43008
    ds_read_b64_tr_b16 a[26:27], v15 offset:44032
    v_fma_f32 v25, v25, v21, v21
    v_rcp_f32 v24, v24
    v_rcp_f32 v25, v25
    v_mfma_f32_32x32x16_bf16 v[192:207], a[4:7], v[52:55], v[192:207]
    s_waitcnt lgkmcnt(6)
    ds_read_b64_tr_b16 a[28:29], v15 offset:47104
    ds_read_b64_tr_b16 a[30:31], v15 offset:48128
    v_mul_f32 v176, v24, v176
    v_mul_f32 v177, v25, v177
    v_mul_f32 v27, v20, v179
    v_exp_f32 v26, v26
    v_mfma_f32_32x32x16_bf16 v[192:207], a[8:11], v[56:59], v[192:207]
    ds_read_b64_tr_b16 a[0:1], v15 offset:51200
    ds_read_b64_tr_b16 a[2:3], v15 offset:52224
    v_exp_f32 v27, v27
    v_fma_f32 v26, v26, v21, v21
    v_fma_f32 v27, v27, v21, v21
    v_mul_f32 v28, v20, v180
    v_mfma_f32_32x32x16_bf16 v[192:207], a[12:15], v[60:63], v[192:207]
    s_waitcnt lgkmcnt(0)
    s_or_b64 s[44:45], s[44:45], s[46:47]
    s_or_b32 s44, s44, s45
    s_and_b32 s44, s44, 33686018
    s_cbranch_scc1 L_slow1
L_back1:
    ds_read_b64_tr_b16 a[4:5], v15 offset:55296
    ds_read_b64_tr_b16 a[6:7], v15 offset:56320
    v_mul_f32 v29, v20, v181
    v_mfma_f32_32x32x16_bf16 v[192:207], a[16:19], v[64:67], v[192:207]
    ds_read_b64_tr_b16 a[8:9], v15 offset:59392
    ds_read_b64_tr_b16 a[10:11], v15 offset:60416
    buffer_load_dwordx4 a[200:203], v6, s[24:27], s58 offen offset:0 sc1
    v_rcp_f32 v26, v26
    v_mul_f32 v30, v20, v182
    v_mfma_f32_32x32x16_bf16 v[192:207], a[20:23], v[68:71], v[192:207]
    s_waitcnt vmcnt(9)
    ds_read_b64_tr_b16 a[12:13], v15 offset:63488
    ds_read_b64_tr_b16 a[14:15], v15 offset:64512
    buffer_store_byte v240, v241, s[24:27], s71 offen sc1
    v_mov_b32 v240, 0
    v_rcp_f32 v27, v27
    v_mfma_f32_32x32x16_bf16 v[192:207], a[24:27], v[72:75], v[192:207]
    ds_read_b64_tr_b16 a[16:17], v17 offset:2048
    ds_read_b64_tr_b16 a[18:19], v17 offset:3072
    buffer_load_dwordx4 a[204:207], v6, s[24:27], s58 offen offset:1024 sc1
    v_mul_f32 v178, v26, v178
    v_mul_f32 v179, v27, v179
    v_mul_f32 v31, v20, v183
    v_mfma_f32_32x32x16_bf16 v[192:207], a[28:31], v[76:79], v[192:207]
    s_waitcnt lgkmcnt(6)
    ds_read_b64_tr_b16 a[20:21], v17 offset:6144
    ds_read_b64_tr_b16 a[22:23], v17 offset:7168
    v_exp_f32 v28, v28
    v_exp_f32 v29, v29
    v_fma_f32 v28, v28, v21, v21
    v_mfma_f32_32x32x16_bf16 v[192:207], a[0:3], v[80:83], v[192:207]
    ds_read_b64_tr_b16 a[24:25], v17 offset:10240
    ds_read_b64_tr_b16 a[26:27], v17 offset:11264
    buffer_load_dwordx4 a[208:211], v6, s[24:27], s59 offen offset:0 sc1
    v_fma_f32 v29, v29, v21, v21
    v_rcp_f32 v28, v28
    v_mfma_f32_32x32x16_bf16 v[192:207], a[4:7], v[84:87], v[192:207]
    s_waitcnt lgkmcnt(6)
    ds_read_b64_tr_b16 a[28:29], v17 offset:14336
    ds_read_b64_tr_b16 a[30:31], v17 offset:15360
    v_rcp_f32 v29, v29
    v_mul_f32 v180, v28, v180
    v_mul_f32 v181, v29, v181
    v_mul_f32 v24, v20, v184
    v_mfma_f32_32x32x16_bf16 v[192:207], a[8:11], v[88:91], v[192:207]
    ds_read_b64_tr_b16 a[0:1], v17 offset:18432
    ds_read_b64_tr_b16 a[2:3], v17 offset:19456
    buffer_load_dwordx4 a[212:215], v6, s[24:27], s59 offen offset:1024 sc1
    v_exp_f32 v30, v30
    v_mul_f32 v25, v20, v185
    v_mfma_f32_32x32x16_bf16 v[192:207], a[12:15], v[92:95], v[192:207]
    s_waitcnt lgkmcnt(6)
    ds_read_b64_tr_b16 a[4:5], v17 offset:22528
    ds_read_b64_tr_b16 a[6:7], v17 offset:23552
    v_exp_f32 v31, v31
    v_fma_f32 v30, v30, v21, v21
    v_fma_f32 v31, v31, v21, v21
    v_mul_f32 v26, v20, v186
    v_mfma_f32_32x32x16_bf16 v[192:207], a[16:19], v[96:99], v[192:207]
    s_barrier
    ds_read_b64_tr_b16 a[8:9], v17 offset:26624
    ds_read_b64_tr_b16 a[10:11], v17 offset:27648
    buffer_load_dwordx4 a[216:219], v6, s[24:27], s60 offen offset:0 sc1
    v_rcp_f32 v30, v30
    v_mfma_f32_32x32x16_bf16 v[192:207], a[20:23], v[100:103], v[192:207]
    s_waitcnt lgkmcnt(6)
    ds_read_b64_tr_b16 a[12:13], v17 offset:30720
    ds_read_b64_tr_b16 a[14:15], v17 offset:31744
    v_rcp_f32 v31, v31
    v_mul_f32 v182, v30, v182
    v_mul_f32 v183, v31, v183
    v_mul_f32 v27, v20, v187
    v_mfma_f32_32x32x16_bf16 v[192:207], a[24:27], v[104:107], v[192:207]
    ds_read_b64_tr_b16 a[16:17], v17 offset:34816
    ds_read_b64_tr_b16 a[18:19], v17 offset:35840
    buffer_load_dwordx4 a[220:223], v6, s[24:27], s60 offen offset:1024 sc1
    v_exp_f32 v24, v24
    v_mul_f32 v28, v20, v188
    v_mfma_f32_32x32x16_bf16 v[192:207], a[28:31], v[108:111], v[192:207]
    s_waitcnt lgkmcnt(6)
    ds_read_b64_tr_b16 a[20:21], v17 offset:38912
    ds_read_b64_tr_b16 a[22:23], v17 offset:39936
    v_exp_f32 v25, v25
    v_fma_f32 v24, v24, v21, v21
    v_fma_f32 v25, v25, v21, v21
    v_mul_f32 v29, v20, v189
    v_mfma_f32_32x32x16_bf16 v[192:207], a[0:3], v[112:115], v[192:207]
    ds_read_b64_tr_b16 a[24:25], v17 offset:43008
    ds_read_b64_tr_b16 a[26:27], v17 offset:44032
    buffer_load_dwordx4 a[224:227], v6, s[24:27], s61 offen offset:0 sc1
    v_rcp_f32 v24, v24
    v_mul_f32 v30, v20, v190
    v_mfma_f32_32x32x16_bf16 v[192:207], a[4:7], v[116:119], v[192:207]
    s_waitcnt lgkmcnt(6)
    ds_read_b64_tr_b16 a[28:29], v17 offset:47104
    ds_read_b64_tr_b16 a[30:31], v17 offset:48128
    v_rcp_f32 v25, v25
    v_mul_f32 v184, v24, v184
    v_mul_f32 v185, v25, v185
    v_mul_f32 v31, v20, v191
    v_mfma_f32_32x32x16_bf16 v[192:207], a[8:11], v[120:123], v[192:207]
    buffer_load_dwordx4 a[228:231], v6, s[24:27], s61 offen offset:1024 sc1
    v_exp_f32 v26, v26
    v_exp_f32 v27, v27
    v_fma_f32 v26, v26, v21, v21
    v_fma_f32 v27, v27, v21, v21
    v_mfma_f32_32x32x16_bf16 v[192:207], a[12:15], v[124:127], v[192:207]
    s_waitcnt lgkmcnt(4)
    v_rcp_f32 v26, v26
    v_rcp_f32 v27, v27
    v_mul_f32 v186, v26, v186
    v_mul_f32 v187, v27, v187
    v_exp_f32 v28, v28
    v_mfma_f32_32x32x16_bf16 v[192:207], a[16:19], v[128:131], v[192:207]
    buffer_load_dwordx4 a[232:235], v6, s[24:27], s62 offen offset:0 sc1
    v_exp_f32 v29, v29
    v_fma_f32 v28, v28, v21, v21
    v_fma_f32 v29, v29, v21, v21
    v_rcp_f32 v28, v28
    v_mfma_f32_32x32x16_bf16 v[192:207], a[20:23], v[132:135], v[192:207]
    s_waitcnt lgkmcnt(0)
    v_rcp_f32 v29, v29
    v_mul_f32 v188, v28, v188
    v_mul_f32 v189, v29, v189
    v_exp_f32 v30, v30
    v_exp_f32 v31, v31
    v_mfma_f32_32x32x16_bf16 v[192:207], a[24:27], v[136:139], v[192:207]
    buffer_load_dwordx4 a[236:239], v6, s[24:27], s62 offen offset:1024 sc1
    v_fma_f32 v30, v30, v21, v21
    v_fma_f32 v31, v31, v21, v21
    v_rcp_f32 v30, v30
    v_rcp_f32 v31, v31
    v_mfma_f32_32x32x16_bf16 v[192:207], a[28:31], v[140:143], v[192:207]
    v_mul_f32 v190, v30, v190
    v_mul_f32 v191, v31, v191
    v_mfma_f32_32x32x16_bf16 v[208:223], a[32:35], a[144:147], 0
    buffer_load_dwordx4 a[240:243], v6, s[24:27], s63 offen offset:0 sc1
    v_mfma_f32_32x32x16_bf16 v[224:239], a[32:35], a[148:151], 0
    v_mfma_f32_32x32x16_bf16 v[144:159], a[36:39], a[144:147], 0
    buffer_load_dwordx4 a[244:247], v6, s[24:27], s63 offen offset:1024 sc1
    s_nop 4
    v_mul_f32 v176, v176, v192
    v_mul_f32 v177, v177, v193
    v_mul_f32 v178, v178, v194
    v_mul_f32 v179, v179, v195
    v_mul_f32 v180, v180, v196
    v_mul_f32 v181, v181, v197
    v_mfma_f32_32x32x16_bf16 v[160:175], a[36:39], a[148:151], 0
    v_mul_f32 v182, v182, v198
    v_mul_f32 v183, v183, v199
    v_mul_f32 v184, v184, v200
    v_mul_f32 v185, v185, v201
    v_mul_f32 v186, v186, v202
    v_mul_f32 v187, v187, v203
    v_mul_f32 v188, v188, v204
    v_mul_f32 v189, v189, v205
    v_mfma_f32_32x32x16_bf16 v[208:223], a[40:43], a[152:155], v[208:223]
    buffer_load_dwordx4 a[248:251], v6, s[24:27], s64 offen offset:0 sc1
    v_mul_f32 v190, v190, v206
    v_mul_f32 v191, v191, v207
    v_cvt_pk_bf16_f32 v192, v176, v177
    v_cvt_pk_bf16_f32 v193, v178, v179
    v_cvt_pk_bf16_f32 v194, v180, v181
    v_cvt_pk_bf16_f32 v195, v182, v183
    v_mfma_f32_32x32x16_bf16 v[224:239], a[40:43], a[156:159], v[224:239]
    v_cvt_pk_bf16_f32 v196, v184, v185
    v_cvt_pk_bf16_f32 v197, v186, v187
    v_cvt_pk_bf16_f32 v198, v188, v189
    v_cvt_pk_bf16_f32 v199, v190, v191
    v_mfma_f32_32x32x16_bf16 v[144:159], a[44:47], a[152:155], v[144:159]
    s_mul_i32 s40, s36, 57344
    s_mul_i32 s41, s3, 14336
    s_add_u32 s40, s40, s41
    s_add_u32 s40, s40, 6291456
    buffer_load_dwordx4 a[252:255], v6, s[24:27], s64 offen offset:1024 sc1
    v_add_u32 v6, s68, v6
    v_mfma_f32_32x32x16_bf16 v[160:175], a[44:47], a[156:159], v[160:175]
    s_load_dwordx4 s[44:47], s[24:25], s48 glc
    buffer_store_dwordx4 v[192:195], v7, s[24:27], 0 offen sc1
    v_lshl_add_u32 v12, v1, 4, s40
    v_lshl_add_u32 v12, v2, 10, v12
    v_and_b32 v13, 0xfffffff7, v243
    v_mfma_f32_32x32x16_bf16 v[208:223], a[48:51], a[160:163], v[208:223]
    s_add_u32 m0, s42, 0
    s_mul_i32 s40, s36, 1792
    s_lshl_b32 s41, s7, 7
    s_add_u32 s40, s40, s41
    s_lshl_b32 s41, s3, 3
    buffer_load_dwordx4 v4, s[20:23], s64 offen lds
    v_mfma_f32_32x32x16_bf16 v[224:239], a[48:51], a[164:167], v[224:239]
    buffer_store_dwordx4 v[196:199], v7, s[24:27], s69 offen sc1
    v_lshrrev_b32 v22, 3, v3
    v_add_u32 v22, s41, v22
    v_mul_u32_u24 v18, 57344, v22
    v_and_b32 v23, 7, v3
    v_lshl_add_u32 v18, v23, 4, v18
    v_mfma_f32_32x32x16_bf16 v[144:159], a[52:55], a[160:163], v[144:159]
    buffer_load_dwordx4 v5, s[20:23], s64 offen offset:1024 lds
    v_add_u32 v4, s65, v4
    v_add_u32 v5, s65, v5
    v_add_u32 v18, s40, v18
    v_and_b32 v19, 3, v3
    v_lshlrev_b32 v23, 2, v19
    v_mfma_f32_32x32x16_bf16 v[160:175], a[52:55], a[164:167], v[160:175]
    v_xor_b32 v22, v22, v23
    v_lshlrev_b32 v22, 4, v22
    v_lshl_add_u32 v19, v19, 10, v22
    v_bfe_u32 v22, v3, 2, 1
    v_lshl_add_u32 v19, v22, 15, v19
    v_xor_b32 v14, 0, v3
    v_xor_b32 v15, 4, v3
    v_mfma_f32_32x32x16_bf16 v[208:223], a[56:59], a[168:171], v[208:223]
    s_add_u32 m0, s42, 2048
    s_nop 0
    buffer_load_dwordx4 v4, s[20:23], s58 offen lds
    v_xor_b32 v16, 8, v3
    v_xor_b32 v17, 12, v3
    v_lshl_add_u32 v14, v14, 4, s42
    v_lshl_add_u32 v15, v15, 4, s42
    v_mfma_f32_32x32x16_bf16 v[224:239], a[56:59], a[172:175], v[224:239]
    v_lshl_add_u32 v16, v16, 4, s42
    v_lshl_add_u32 v17, v17, 4, s42
    v_mfma_f32_32x32x16_bf16 v[144:159], a[60:63], a[168:171], v[144:159]
    s_lshl_b32 s40, s7, 6
    buffer_load_dwordx4 v5, s[20:23], s58 offen offset:1024 lds
    v_add_u32 v244, s40, v1
    v_cvt_f32_u32 v244, v244
    v_add_f32 v245, 0x42000000, v244
    v_mul_f32 v244, 0x3b124925, v244
    v_mfma_f32_32x32x16_bf16 v[160:175], a[60:63], a[172:175], v[160:175]
    s_waitcnt vmcnt(27)
    v_mul_f32 v245, 0x3b124925, v245
    v_mfma_f32_32x32x16_bf16 v[208:223], a[64:67], a[176:179], v[208:223]
    s_add_u32 m0, s42, 16384
    s_mul_i32 s40, s3, 56
    s_add_u32 s40, s40, 1
    buffer_load_dwordx4 v4, s[20:23], s59 offen lds
    v_lshl_add_u32 v246, v2, 2, s40
    v_cvt_f32_u32 v246, v246
    v_mfma_f32_32x32x16_bf16 v[224:239], a[64:67], a[180:183], v[224:239]
    v_mul_f32 v247, v246, v245
    v_mul_f32 v246, v246, v244
    v_fract_f32 v246, v246
    v_fract_f32 v247, v247
    v_mul_f32 v24, 0x41000000, v244
    v_mul_f32 v25, 0x41000000, v245
    v_fmamk_f32 v180, v244, 0x00000000, v246
    v_mfma_f32_32x32x16_bf16 v[144:159], a[68:71], a[176:179], v[144:159]
    buffer_load_dwordx4 v5, s[20:23], s59 offen offset:1024 lds
    v_cos_f32 v24, v24
    v_cos_f32 v25, v25
    v_add_f32 v24, v24, v24
    v_mfma_f32_32x32x16_bf16 v[160:175], a[68:71], a[180:183], v[160:175]
    s_waitcnt vmcnt(27)
    v_add_f32 v25, v25, v25
    v_fmamk_f32 v181, v244, 0x3f800000, v246
    v_fmamk_f32 v182, v244, 0x40000000, v246
    v_fmamk_f32 v183, v244, 0x40400000, v246
    v_cos_f32 v176, v180
    v_fmamk_f32 v196, v245, 0x00000000, v247
    v_mfma_f32_32x32x16_bf16 v[208:223], a[72:75], a[184:187], v[208:223]
    s_add_u32 m0, s42, 18432
    s_nop 0
    buffer_load_dwordx4 v4, s[20:23], s60 offen lds
    v_sin_f32 v180, v180
    v_cos_f32 v177, v181
    v_mfma_f32_32x32x16_bf16 v[224:239], a[72:75], a[188:191], v[224:239]
    s_waitcnt lgkmcnt(0)
    s_or_b64 s[44:45], s[44:45], s[46:47]
    s_or_b32 s44, s44, s45
    s_and_b32 s44, s44, 67372036
    s_cbranch_scc1 L_slow2
L_back2:
    v_sin_f32 v181, v181
    v_cos_f32 v178, v182
    v_mfma_f32_32x32x16_bf16 v[144:159], a[76:79], a[184:187], v[144:159]
    buffer_load_dwordx4 v5, s[20:23], s60 offen offset:1024 lds
    v_sin_f32 v182, v182
    v_cos_f32 v179, v183
    v_cvt_pk_bf16_f32 v32, v176, -v180
    v_mfma_f32_32x32x16_bf16 v[160:175], a[76:79], a[188:191], v[160:175]
    s_waitcnt vmcnt(27)
    v_sin_f32 v183, v183
    v_cvt_pk_bf16_f32 v33, v177, -v181
    v_cvt_pk_bf16_f32 v34, v178, -v182
    v_cvt_pk_bf16_f32 v35, v179, -v183
    v_fmamk_f32 v197, v245, 0x3f800000, v247
    v_fmamk_f32 v198, v245, 0x40000000, v247
    v_mfma_f32_32x32x16_bf16 v[208:223], a[80:83], a[192:195], v[208:223]
    buffer_load_dwordx4 a[144:147], v6, s[24:27], s58 offen offset:0 sc1
    v_fmamk_f32 v199, v245, 0x40400000, v247
    v_cos_f32 v192, v196
    v_sin_f32 v196, v196
    v_mfma_f32_32x32x16_bf16 v[224:239], a[80:83], a[196:199], v[224:239]
    v_cos_f32 v193, v197
    v_sin_f32 v197, v197
    v_cos_f32 v194, v198
    v_cvt_pk_bf16_f32 v36, v192, -v196
    v_mfma_f32_32x32x16_bf16 v[144:159], a[84:87], a[192:195], v[144:159]
    buffer_load_dwordx4 a[148:151], v6, s[24:27], s58 offen offset:1024 sc1
    v_sin_f32 v198, v198
    v_cos_f32 v195, v199
    v_cvt_pk_bf16_f32 v37, v193, -v197
    v_mfma_f32_32x32x16_bf16 v[160:175], a[84:87], a[196:199], v[160:175]
    s_waitcnt vmcnt(24)
    v_sin_f32 v199, v199
    v_cvt_pk_bf16_f32 v38, v194, -v198
    v_cvt_pk_bf16_f32 v39, v195, -v199
    v_fmamk_f32 v188, v244, 0x41000000, v246
    v_fmamk_f32 v189, v244, 0x41100000, v246
    v_fmamk_f32 v190, v244, 0x41200000, v246
    v_mfma_f32_32x32x16_bf16 v[208:223], a[88:91], a[200:203], v[208:223]
    buffer_load_dwordx4 a[152:155], v6, s[24:27], s59 offen offset:0 sc1
    v_fmamk_f32 v191, v244, 0x41300000, v246
    v_cos_f32 v184, v188
    v_sin_f32 v188, v188
    v_mfma_f32_32x32x16_bf16 v[224:239], a[88:91], a[204:207], v[224:239]
    v_cos_f32 v185, v189
    v_sin_f32 v189, v189
    v_cos_f32 v186, v190
    v_cvt_pk_bf16_f32 v40, v184, -v188
    v_mfma_f32_32x32x16_bf16 v[144:159], a[92:95], a[200:203], v[144:159]
    buffer_load_dwordx4 a[156:159], v6, s[24:27], s59 offen offset:1024 sc1
    v_sin_f32 v190, v190
    v_cos_f32 v187, v191
    v_cvt_pk_bf16_f32 v41, v185, -v189
    v_mfma_f32_32x32x16_bf16 v[160:175], a[92:95], a[204:207], v[160:175]
    s_waitcnt vmcnt(11)
    buffer_store_byte v240, v241, s[24:27], s71 offen sc1
    v_mov_b32 v240, 0
    v_sin_f32 v191, v191
    v_cvt_pk_bf16_f32 v42, v186, -v190
    v_mfma_f32_32x32x16_bf16 v[208:223], a[96:99], a[208:211], v[208:223]
    buffer_load_dwordx4 a[160:163], v6, s[24:27], s60 offen offset:0 sc1
    v_cvt_pk_bf16_f32 v43, v187, -v191
    v_fmamk_f32 v204, v245, 0x41000000, v247
    v_fmamk_f32 v205, v245, 0x41100000, v247
    v_fmamk_f32 v206, v245, 0x41200000, v247
    v_fmamk_f32 v207, v245, 0x41300000, v247
    v_mfma_f32_32x32x16_bf16 v[224:239], a[96:99], a[212:215], v[224:239]
    v_cos_f32 v200, v204
    v_sin_f32 v204, v204
    v_cos_f32 v201, v205
    v_cvt_pk_bf16_f32 v44, v200, -v204
    v_mfma_f32_32x32x16_bf16 v[144:159], a[100:103], a[208:211], v[144:159]
    buffer_load_dwordx4 a[164:167], v6, s[24:27], s60 offen offset:1024 sc1
    v_sin_f32 v205, v205
    v_cos_f32 v202, v206
    v_cvt_pk_bf16_f32 v45, v201, -v205
    v_mfma_f32_32x32x16_bf16 v[160:175], a[100:103], a[212:215], v[160:175]
    v_sin_f32 v206, v206
    v_cos_f32 v203, v207
    v_sin_f32 v207, v207
    v_cvt_pk_bf16_f32 v46, v202, -v206
    v_mfma_f32_32x32x16_bf16 v[208:223], a[104:107], a[216:219], v[208:223]
    buffer_load_dwordx4 a[168:171], v6, s[24:27], s61 offen offset:0 sc1
    v_cvt_pk_bf16_f32 v47, v203, -v207
    v_fma_f32 v176, v184, v24, -v176
    v_fma_f32 v177, v185, v24, -v177
    v_fma_f32 v178, v186, v24, -v178
    v_fma_f32 v179, v187, v24, -v179
    v_mfma_f32_32x32x16_bf16 v[224:239], a[104:107], a[220:223], v[224:239]
    v_fma_f32 v180, v188, v24, -v180
    v_fma_f32 v181, v189, v24, -v181
    v_fma_f32 v182, v190, v24, -v182
    v_fma_f32 v183, v191, v24, -v183
    v_cvt_pk_bf16_f32 v48, v176, -v180
    v_cvt_pk_bf16_f32 v49, v177, -v181
    v_cvt_pk_bf16_f32 v50, v178, -v182
    v_mfma_f32_32x32x16_bf16 v[144:159], a[108:111], a[216:219], v[144:159]
    buffer_load_dwordx4 a[172:175], v6, s[24:27], s61 offen offset:1024 sc1
    v_cvt_pk_bf16_f32 v51, v179, -v183
    v_fma_f32 v192, v200, v25, -v192
    v_fma_f32 v193, v201, v25, -v193
    v_fma_f32 v194, v202, v25, -v194
    v_fma_f32 v195, v203, v25, -v195
    v_mfma_f32_32x32x16_bf16 v[160:175], a[108:111], a[220:223], v[160:175]
    v_fma_f32 v196, v204, v25, -v196
    v_fma_f32 v197, v205, v25, -v197
    v_fma_f32 v198, v206, v25, -v198
    v_fma_f32 v199, v207, v25, -v199
    v_cvt_pk_bf16_f32 v52, v192, -v196
    v_cvt_pk_bf16_f32 v53, v193, -v197
    v_cvt_pk_bf16_f32 v54, v194, -v198
    v_mfma_f32_32x32x16_bf16 v[208:223], a[112:115], a[224:227], v[208:223]
    buffer_load_dwordx4 a[176:179], v6, s[24:27], s62 offen offset:0 sc1
    v_cvt_pk_bf16_f32 v55, v195, -v199
    v_fma_f32 v184, v176, v24, -v184
    v_fma_f32 v185, v177, v24, -v185
    v_fma_f32 v186, v178, v24, -v186
    v_fma_f32 v187, v179, v24, -v187
    v_mfma_f32_32x32x16_bf16 v[224:239], a[112:115], a[228:231], v[224:239]
    v_fma_f32 v188, v180, v24, -v188
    v_fma_f32 v189, v181, v24, -v189
    v_fma_f32 v190, v182, v24, -v190
    v_fma_f32 v191, v183, v24, -v191
    v_cvt_pk_bf16_f32 v56, v184, -v188
    v_cvt_pk_bf16_f32 v57, v185, -v189
    v_cvt_pk_bf16_f32 v58, v186, -v190
    v_mfma_f32_32x32x16_bf16 v[144:159], a[116:119], a[224:227], v[144:159]
    buffer_load_dwordx4 a[180:183], v6, s[24:27], s62 offen offset:1024 sc1
    v_cvt_pk_bf16_f32 v59, v187, -v191
    v_fma_f32 v200, v192, v25, -v200
    v_fma_f32 v201, v193, v25, -v201
    v_fma_f32 v202, v194, v25, -v202
    v_fma_f32 v203, v195, v25, -v203
    v_mfma_f32_32x32x16_bf16 v[160:175], a[116:119], a[228:231], v[160:175]
    v_fma_f32 v204, v196, v25, -v204
    v_fma_f32 v205, v197, v25, -v205
    v_fma_f32 v206, v198, v25, -v206
    v_fma_f32 v207, v199, v25, -v207
    v_cvt_pk_bf16_f32 v60, v200, -v204
    v_cvt_pk_bf16_f32 v61, v201, -v205
    v_cvt_pk_bf16_f32 v62, v202, -v206
    v_mfma_f32_32x32x16_bf16 v[208:223], a[120:123], a[232:235], v[208:223]
    buffer_load_dwordx4 a[184:187], v6, s[24:27], s63 offen offset:0 sc1
    v_cvt_pk_bf16_f32 v63, v203, -v207
    v_fma_f32 v176, v184, v24, -v176
    v_fma_f32 v177, v185, v24, -v177
    v_fma_f32 v178, v186, v24, -v178
    v_fma_f32 v179, v187, v24, -v179
    v_mfma_f32_32x32x16_bf16 v[224:239], a[120:123], a[236:239], v[224:239]
    v_fma_f32 v180, v188, v24, -v180
    v_fma_f32 v181, v189, v24, -v181
    v_fma_f32 v182, v190, v24, -v182
    v_fma_f32 v183, v191, v24, -v183
    v_cvt_pk_bf16_f32 v64, v176, -v180
    v_cvt_pk_bf16_f32 v65, v177, -v181
    v_cvt_pk_bf16_f32 v66, v178, -v182
    v_mfma_f32_32x32x16_bf16 v[144:159], a[124:127], a[232:235], v[144:159]
    buffer_load_dwordx4 a[188:191], v6, s[24:27], s63 offen offset:1024 sc1
    v_cvt_pk_bf16_f32 v67, v179, -v183
    v_fma_f32 v192, v200, v25, -v192
    v_fma_f32 v193, v201, v25, -v193
    v_fma_f32 v194, v202, v25, -v194
    v_fma_f32 v195, v203, v25, -v195
    v_mfma_f32_32x32x16_bf16 v[160:175], a[124:127], a[236:239], v[160:175]
    ds_read_b64_tr_b16 a[32:33], v8 offset:4096
    ds_read_b64_tr_b16 a[34:35], v8 offset:5120
    v_fma_f32 v196, v204, v25, -v196
    v_fma_f32 v197, v205, v25, -v197
    v_fma_f32 v198, v206, v25, -v198
    v_fma_f32 v199, v207, v25, -v199
    v_mfma_f32_32x32x16_bf16 v[208:223], a[128:131], a[240:243], v[208:223]
    buffer_load_dwordx4 a[192:195], v6, s[24:27], s64 offen offset:0 sc1
    v_cvt_pk_bf16_f32 v68, v192, -v196
    v_cvt_pk_bf16_f32 v69, v193, -v197
    v_cvt_pk_bf16_f32 v70, v194, -v198
    v_cvt_pk_bf16_f32 v71, v195, -v199
    v_fma_f32 v184, v176, v24, -v184
    v_mfma_f32_32x32x16_bf16 v[224:239], a[128:131], a[244:247], v[224:239]
    s_load_dwordx2 s[44:45], s[24:25], s49 glc
    ds_read_b64_tr_b16 a[36:37], v9 offset:4096
    ds_read_b64_tr_b16 a[38:39], v9 offset:5120
    buffer_load_dwordx4 a[196:199], v6, s[24:27], s64 offen offset:1024 sc1
    v_add_u32 v6, s67, v6
    v_fma_f32 v185, v177, v24, -v185
    v_mfma_f32_32x32x16_bf16 v[144:159], a[132:135], a[240:243], v[144:159]
    v_fma_f32 v186, v178, v24, -v186
    v_fma_f32 v187, v179, v24, -v187
    v_fma_f32 v188, v180, v24, -v188
    v_fma_f32 v189, v181, v24, -v189
    v_fma_f32 v190, v182, v24, -v190
    v_fma_f32 v191, v183, v24, -v191
    v_cvt_pk_bf16_f32 v72, v184, -v188
    v_mfma_f32_32x32x16_bf16 v[160:175], a[132:135], a[244:247], v[160:175]
    s_add_u32 m0, s42, 32768
    ds_read_b64_tr_b16 a[40:41], v8 offset:6144
    ds_read_b64_tr_b16 a[42:43], v8 offset:7168
    buffer_load_dwordx4 v4, s[20:23], s61 offen lds
    v_cvt_pk_bf16_f32 v73, v185, -v189
    v_mfma_f32_32x32x16_bf16 v[208:223], a[136:139], a[248:251], v[208:223]
    buffer_load_dwordx4 v5, s[20:23], s61 offen offset:1024 lds
    v_cvt_pk_bf16_f32 v74, v186, -v190
    v_cvt_pk_bf16_f32 v75, v187, -v191
    v_fma_f32 v200, v192, v25, -v200
    v_fma_f32 v201, v193, v25, -v201
    v_fma_f32 v202, v194, v25, -v202
    v_mfma_f32_32x32x16_bf16 v[224:239], a[136:139], a[252:255], v[224:239]
    ds_read_b64_tr_b16 a[44:45], v9 offset:6144
    ds_read_b64_tr_b16 a[46:47], v9 offset:7168
    v_fma_f32 v203, v195, v25, -v203
    v_fma_f32 v204, v196, v25, -v204
    v_fma_f32 v205, v197, v25, -v205
    v_fma_f32 v206, v198, v25, -v206
    v_mfma_f32_32x32x16_bf16 v[144:159], a[140:143], a[248:251], v[144:159]
    s_waitcnt lgkmcnt(4)
    s_add_u32 m0, s42, 34816
    s_nop 0
    buffer_load_dwordx4 v4, s[20:23], s62 offen lds
    v_fma_f32 v207, v199, v25, -v207
    v_cvt_pk_bf16_f32 v76, v200, -v204
    v_cvt_pk_bf16_f32 v77, v201, -v205
    v_mfma_f32_32x32x16_bf16 v[160:175], a[140:143], a[252:255], v[160:175]
    s_waitcnt vmcnt(16)
    ds_read_b64_tr_b16 a[48:49], v8 offset:8192
    ds_read_b64_tr_b16 a[50:51], v8 offset:9216
    buffer_load_dwordx4 v5, s[20:23], s62 offen offset:1024 lds
    v_cvt_pk_bf16_f32 v78, v202, -v206
    v_cvt_pk_bf16_f32 v79, v203, -v207
    v_mfma_f32_32x32x16_bf16 v[208:223], a[32:35], a[144:147], v[208:223]
    v_fma_f32 v176, v184, v24, -v176
    v_fma_f32 v177, v185, v24, -v177
    v_fma_f32 v178, v186, v24, -v178
    v_fma_f32 v179, v187, v24, -v179
    v_fma_f32 v180, v188, v24, -v180
    v_fma_f32 v181, v189, v24, -v181
    v_fma_f32 v182, v190, v24, -v182
    v_mfma_f32_32x32x16_bf16 v[224:239], a[32:35], a[148:151], v[224:239]
    s_add_u32 m0, s42, 49152
    ds_read_b64_tr_b16 a[52:53], v9 offset:8192
    ds_read_b64_tr_b16 a[54:55], v9 offset:9216
    buffer_load_dwordx4 v4, s[20:23], s63 offen lds
    v_fma_f32 v183, v191, v24, -v183
    v_cvt_pk_bf16_f32 v80, v176, -v180
    v_mfma_f32_32x32x16_bf16 v[144:159], a[36:39], a[144:147], v[144:159]
    s_waitcnt lgkmcnt(4)
    buffer_load_dwordx4 v5, s[20:23], s63 offen offset:1024 lds
    v_cvt_pk_bf16_f32 v81, v177, -v181
    v_cvt_pk_bf16_f32 v82, v178, -v182
    v_cvt_pk_bf16_f32 v83, v179, -v183
    v_fma_f32 v192, v200, v25, -v192
    v_mfma_f32_32x32x16_bf16 v[160:175], a[36:39], a[148:151], v[160:175]
    s_waitcnt vmcnt(17)
    ds_read_b64_tr_b16 a[56:57], v8 offset:10240
    ds_read_b64_tr_b16 a[58:59], v8 offset:11264
    v_fma_f32 v193, v201, v25, -v193
    v_fma_f32 v194, v202, v25, -v194
    v_fma_f32 v195, v203, v25, -v195
    v_fma_f32 v196, v204, v25, -v196
    v_mfma_f32_32x32x16_bf16 v[208:223], a[40:43], a[152:155], v[208:223]
    s_add_u32 m0, s42, 51200
    s_nop 0
    buffer_load_dwordx4 v4, s[20:23], s64 offen lds
    v_fma_f32 v197, v205, v25, -v197
    v_fma_f32 v198, v206, v25, -v198
    v_fma_f32 v199, v207, v25, -v199
    v_cvt_pk_bf16_f32 v84, v192, -v196
    v_mfma_f32_32x32x16_bf16 v[224:239], a[40:43], a[156:159], v[224:239]
    ds_read_b64_tr_b16 a[60:61], v9 offset:10240
    ds_read_b64_tr_b16 a[62:63], v9 offset:11264
    buffer_load_dwordx4 v5, s[20:23], s64 offen offset:1024 lds
    v_cvt_pk_bf16_f32 v85, v193, -v197
    v_cvt_pk_bf16_f32 v86, v194, -v198
    v_mfma_f32_32x32x16_bf16 v[144:159], a[44:47], a[152:155], v[144:159]
    s_waitcnt lgkmcnt(4)
    v_cvt_pk_bf16_f32 v87, v195, -v199
    v_mfma_f32_32x32x16_bf16 v[160:175], a[44:47], a[156:159], v[160:175]
    s_waitcnt vmcnt(16) lgkmcnt(0)
    s_or_b32 s44, s44, s45
    s_cbranch_scc1 L_slow4
L_back4:
    ds_read_b64_tr_b16 a[64:65], v8 offset:0
    ds_read_b64_tr_b16 a[66:67], v8 offset:1024
    buffer_load_dwordx4 v[248:251], v18, s[8:11], 0 offen
    v_mfma_f32_32x32x16_bf16 v[208:223], a[48:51], a[160:163], v[208:223]
    buffer_load_dwordx4 v[252:255], v18, s[8:11], 0 offen offset:896
    v_mfma_f32_32x32x16_bf16 v[224:239], a[48:51], a[164:167], v[224:239]
    s_load_dwordx4 s[44:47], s[24:25], s48 glc
    ds_read_b64_tr_b16 a[68:69], v9 offset:0
    ds_read_b64_tr_b16 a[70:71], v9 offset:1024
    v_mfma_f32_32x32x16_bf16 v[144:159], a[52:55], a[160:163], v[144:159]
    buffer_load_dwordx4 v[88:91], v12, s[24:27], 0 offen offset:0 sc1
    v_mfma_f32_32x32x16_bf16 v[160:175], a[52:55], a[164:167], v[160:175]
    s_waitcnt vmcnt(17)
    ds_read_b64_tr_b16 a[72:73], v8 offset:2048
    ds_read_b64_tr_b16 a[74:75], v8 offset:3072
    buffer_load_dwordx4 v[92:95], v12, s[24:27], 0 offen offset:512 sc1
    v_mfma_f32_32x32x16_bf16 v[208:223], a[56:59], a[168:171], v[208:223]
    v_mfma_f32_32x32x16_bf16 v[224:239], a[56:59], a[172:175], v[224:239]
    ds_read_b64_tr_b16 a[76:77], v9 offset:2048
    ds_read_b64_tr_b16 a[78:79], v9 offset:3072
    buffer_load_dwordx4 v[96:99], v12, s[24:27], 0 offen offset:2048 sc1
    v_mfma_f32_32x32x16_bf16 v[144:159], a[60:63], a[168:171], v[144:159]
    s_waitcnt lgkmcnt(4)
    buffer_load_dwordx4 v[100:103], v12, s[24:27], 0 offen offset:2560 sc1
    v_add_u32 v12, 4096, v12
    v_mfma_f32_32x32x16_bf16 v[160:175], a[60:63], a[172:175], v[160:175]
    s_waitcnt vmcnt(18)
    ds_read_b64_tr_b16 a[80:81], v10 offset:0
    ds_read_b64_tr_b16 a[82:83], v10 offset:1024
    v_mfma_f32_32x32x16_bf16 v[208:223], a[64:67], a[176:179], v[208:223]
    buffer_load_dwordx4 v[104:107], v12, s[24:27], 0 offen offset:0 sc1
    v_mfma_f32_32x32x16_bf16 v[224:239], a[64:67], a[180:183], v[224:239]
    ds_read_b64_tr_b16 a[84:85], v11 offset:0
    ds_read_b64_tr_b16 a[86:87], v11 offset:1024
    buffer_load_dwordx4 v[108:111], v12, s[24:27], 0 offen offset:512 sc1
    v_mfma_f32_32x32x16_bf16 v[144:159], a[68:71], a[176:179], v[144:159]
    s_waitcnt lgkmcnt(4)
    v_mfma_f32_32x32x16_bf16 v[160:175], a[68:71], a[180:183], v[160:175]
    s_waitcnt vmcnt(18)
    ds_read_b64_tr_b16 a[88:89], v10 offset:2048
    ds_read_b64_tr_b16 a[90:91], v10 offset:3072
    buffer_load_dwordx4 v[112:115], v12, s[24:27], 0 offen offset:2048 sc1
    v_mfma_f32_32x32x16_bf16 v[208:223], a[72:75], a[184:187], v[208:223]
    buffer_load_dwordx4 v[116:119], v12, s[24:27], 0 offen offset:2560 sc1
    v_add_u32 v12, 4096, v12
    v_mfma_f32_32x32x16_bf16 v[224:239], a[72:75], a[188:191], v[224:239]
    ds_read_b64_tr_b16 a[92:93], v11 offset:2048
    ds_read_b64_tr_b16 a[94:95], v11 offset:3072
    v_mfma_f32_32x32x16_bf16 v[144:159], a[76:79], a[184:187], v[144:159]
    s_waitcnt lgkmcnt(4)
    buffer_load_dwordx4 v[120:123], v12, s[24:27], 0 offen offset:0 sc1
    v_mfma_f32_32x32x16_bf16 v[160:175], a[76:79], a[188:191], v[160:175]
    s_waitcnt vmcnt(19) lgkmcnt(0)
    s_or_b64 s[44:45], s[44:45], s[46:47]
    s_or_b32 s44, s44, s45
    s_and_b32 s44, s44, 134744072
    s_cbranch_scc1 L_slow3
L_back3:
    ds_read_b64_tr_b16 a[96:97], v10 offset:16384
    ds_read_b64_tr_b16 a[98:99], v10 offset:17408
    buffer_load_dwordx4 v[124:127], v12, s[24:27], 0 offen offset:512 sc1
    v_mfma_f32_32x32x16_bf16 v[208:223], a[80:83], a[192:195], v[208:223]
    v_mfma_f32_32x32x16_bf16 v[224:239], a[80:83], a[196:199], v[224:239]
    ds_read_b64_tr_b16 a[100:101], v11 offset:16384
    ds_read_b64_tr_b16 a[102:103], v11 offset:17408
    buffer_load_dwordx4 v[128:131], v12, s[24:27], 0 offen offset:2048 sc1
    v_mfma_f32_32x32x16_bf16 v[144:159], a[84:87], a[192:195], v[144:159]
    s_waitcnt vmcnt(9)
    buffer_load_dwordx4 v[132:135], v12, s[24:27], 0 offen offset:2560 sc1
    v_swap_b32 v90, v92
    v_swap_b32 v91, v93
    v_add_u32 v12, 4096, v12
    v_mfma_f32_32x32x16_bf16 v[160:175], a[84:87], a[196:199], v[160:175]
    ds_read_b64_tr_b16 a[104:105], v10 offset:18432
    ds_read_b64_tr_b16 a[106:107], v10 offset:19456
    v_mfma_f32_32x32x16_bf16 v[208:223], v[32:35], v[88:91], v[208:223]
    buffer_load_dwordx4 v[136:139], v12, s[24:27], 0 offen offset:0 sc1
    v_mfma_f32_32x32x16_bf16 v[224:239], v[32:35], v[92:95], v[224:239]
    ds_read_b64_tr_b16 a[108:109], v11 offset:18432
    ds_read_b64_tr_b16 a[110:111], v11 offset:19456
    buffer_load_dwordx4 v[140:143], v12, s[24:27], 0 offen offset:512 sc1
    v_mfma_f32_32x32x16_bf16 v[144:159], v[36:39], v[88:91], v[144:159]
    s_waitcnt vmcnt(10) lgkmcnt(4)
    v_swap_b32 v98, v100
    v_swap_b32 v99, v101
    v_mfma_f32_32x32x16_bf16 v[160:175], v[36:39], v[92:95], v[160:175]
    ds_read_b64_tr_b16 a[112:113], v10 offset:32768
    ds_read_b64_tr_b16 a[114:115], v10 offset:33792
    buffer_load_dwordx4 a[200:203], v6, s[24:27], s58 offen offset:0 sc1
    v_mfma_f32_32x32x16_bf16 v[208:223], v[40:43], v[96:99], v[208:223]
    buffer_load_dwordx4 a[204:207], v6, s[24:27], s58 offen offset:1024 sc1
    v_mfma_f32_32x32x16_bf16 v[224:239], v[40:43], v[100:103], v[224:239]
    ds_read_b64_tr_b16 a[116:117], v11 offset:32768
    ds_read_b64_tr_b16 a[118:119], v11 offset:33792
    v_mfma_f32_32x32x16_bf16 v[144:159], v[44:47], v[96:99], v[144:159]
    s_waitcnt vmcnt(10) lgkmcnt(4)
    buffer_load_dwordx4 a[208:211], v6, s[24:27], s59 offen offset:0 sc1
    v_swap_b32 v106, v108
    v_swap_b32 v107, v109
    v_mfma_f32_32x32x16_bf16 v[160:175], v[44:47], v[100:103], v[160:175]
    ds_read_b64_tr_b16 a[120:121], v10 offset:34816
    ds_read_b64_tr_b16 a[122:123], v10 offset:35840
    buffer_load_dwordx4 a[212:215], v6, s[24:27], s59 offen offset:1024 sc1
    v_mfma_f32_32x32x16_bf16 v[208:223], v[48:51], v[104:107], v[208:223]
    v_mfma_f32_32x32x16_bf16 v[224:239], v[48:51], v[108:111], v[224:239]
    ds_read_b64_tr_b16 a[124:125], v11 offset:34816
    ds_read_b64_tr_b16 a[126:127], v11 offset:35840
    buffer_load_dwordx4 a[216:219], v6, s[24:27], s60 offen offset:0 sc1
    v_mfma_f32_32x32x16_bf16 v[144:159], v[52:55], v[104:107], v[144:159]
    s_waitcnt vmcnt(11) lgkmcnt(4)
    buffer_load_dwordx4 a[220:223], v6, s[24:27], s60 offen offset:1024 sc1
    v_swap_b32 v114, v116
    v_swap_b32 v115, v117
    v_mfma_f32_32x32x16_bf16 v[160:175], v[52:55], v[108:111], v[160:175]
    ds_read_b64_tr_b16 a[128:129], v10 offset:49152
    ds_read_b64_tr_b16 a[130:131], v10 offset:50176
    v_mfma_f32_32x32x16_bf16 v[208:223], v[56:59], v[112:115], v[208:223]
    buffer_load_dwordx4 a[224:227], v6, s[24:27], s61 offen offset:0 sc1
    v_mfma_f32_32x32x16_bf16 v[224:239], v[56:59], v[116:119], v[224:239]
    ds_read_b64_tr_b16 a[132:133], v11 offset:49152
    ds_read_b64_tr_b16 a[134:135], v11 offset:50176
    buffer_load_dwordx4 a[228:231], v6, s[24:27], s61 offen offset:1024 sc1
    v_mfma_f32_32x32x16_bf16 v[144:159], v[60:63], v[112:115], v[144:159]
    s_waitcnt vmcnt(12) lgkmcnt(4)
    v_swap_b32 v122, v124
    v_swap_b32 v123, v125
    v_mfma_f32_32x32x16_bf16 v[160:175], v[60:63], v[116:119], v[160:175]
    ds_read_b64_tr_b16 a[136:137], v10 offset:51200
    ds_read_b64_tr_b16 a[138:139], v10 offset:52224
    buffer_load_dwordx4 a[232:235], v6, s[24:27], s62 offen offset:0 sc1
    v_mfma_f32_32x32x16_bf16 v[208:223], v[64:67], v[120:123], v[208:223]
    buffer_load_dwordx4 a[236:239], v6, s[24:27], s62 offen offset:1024 sc1
    v_mfma_f32_32x32x16_bf16 v[224:239], v[64:67], v[124:127], v[224:239]
    ds_read_b64_tr_b16 a[140:141], v11 offset:51200
    ds_read_b64_tr_b16 a[142:143], v11 offset:52224
    v_mfma_f32_32x32x16_bf16 v[144:159], v[68:71], v[120:123], v[144:159]
    s_waitcnt vmcnt(12) lgkmcnt(4)
    buffer_load_dwordx4 a[240:243], v6, s[24:27], s63 offen offset:0 sc1
    v_swap_b32 v130, v132
    v_swap_b32 v131, v133
    v_mfma_f32_32x32x16_bf16 v[160:175], v[68:71], v[124:127], v[160:175]
    buffer_load_dwordx4 a[244:247], v6, s[24:27], s63 offen offset:1024 sc1
    v_mfma_f32_32x32x16_bf16 v[208:223], v[72:75], v[128:131], v[208:223]
    v_mfma_f32_32x32x16_bf16 v[224:239], v[72:75], v[132:135], v[224:239]
    buffer_load_dwordx4 a[248:251], v6, s[24:27], s64 offen offset:0 sc1
    v_mfma_f32_32x32x16_bf16 v[144:159], v[76:79], v[128:131], v[144:159]
    s_waitcnt vmcnt(13) lgkmcnt(0)
    buffer_load_dwordx4 a[252:255], v6, s[24:27], s64 offen offset:1024 sc1
    v_swap_b32 v138, v140
    v_swap_b32 v139, v141
    v_mfma_f32_32x32x16_bf16 v[160:175], v[76:79], v[132:135], v[160:175]
    s_nop 0
    v_mfma_f32_32x32x16_bf16 v[208:223], v[80:83], v[136:139], v[208:223]
    v_mfma_f32_32x32x16_bf16 v[224:239], v[80:83], v[140:143], v[224:239]
    v_mfma_f32_32x32x16_bf16 v[144:159], v[84:87], v[136:139], v[144:159]
    v_mfma_f32_32x32x16_bf16 v[160:175], v[84:87], v[140:143], v[160:175]
    s_waitcnt vmcnt(12)
    v_mfma_f32_32x32x16_bf16 v[208:223], a[88:91], a[200:203], v[208:223]
    v_mfma_f32_32x32x16_bf16 v[224:239], a[88:91], a[204:207], v[224:239]
    v_mfma_f32_32x32x16_bf16 v[144:159], a[92:95], a[200:203], v[144:159]
    v_mfma_f32_32x32x16_bf16 v[160:175], a[92:95], a[204:207], v[160:175]
    s_waitcnt vmcnt(10)
    v_mfma_f32_32x32x16_bf16 v[208:223], a[96:99], a[208:211], v[208:223]
    s_waitcnt vmcnt(8)
    v_mfma_f32_32x32x16_bf16 v[208:223], a[104:107], a[216:219], v[208:223]
    s_waitcnt vmcnt(6)
    v_mfma_f32_32x32x16_bf16 v[208:223], a[112:115], a[224:227], v[208:223]
    s_waitcnt vmcnt(4)
    v_mfma_f32_32x32x16_bf16 v[208:223], a[120:123], a[232:235], v[208:223]
    s_waitcnt vmcnt(2)
    v_mfma_f32_32x32x16_bf16 v[208:223], a[128:131], a[240:243], v[208:223]
    s_waitcnt vmcnt(0)
    v_mfma_f32_32x32x16_bf16 v[208:223], a[136:139], a[248:251], v[208:223]
    v_mfma_f32_32x32x16_bf16 v[144:159], a[100:103], a[208:211], v[144:159]
    s_nop 5
    v_mfma_f32_32x32x16_bf16 v[144:159], a[108:111], a[216:219], v[144:159]
    s_nop 3
    ds_write_b128 v14, v[208:211] offset:0
    v_mfma_f32_32x32x16_bf16 v[144:159], a[116:119], a[224:227], v[144:159]
    ds_write_b128 v15, v[212:215] offset:1024
    v_lshlrev_b32 v176, 16, v248
    v_and_b32 v177, 0xffff0000, v248
    v_lshlrev_b32 v178, 16, v249
    v_and_b32 v179, 0xffff0000, v249
    v_mfma_f32_32x32x16_bf16 v[144:159], a[124:127], a[232:235], v[144:159]
    ds_write_b128 v16, v[216:219] offset:2048
    v_lshlrev_b32 v180, 16, v250
    v_and_b32 v181, 0xffff0000, v250
    v_lshlrev_b32 v182, 16, v251
    v_and_b32 v183, 0xffff0000, v251
    v_mfma_f32_32x32x16_bf16 v[144:159], a[132:135], a[240:243], v[144:159]
    ds_write_b128 v17, v[220:223] offset:3072
    v_lshlrev_b32 v184, 16, v252
    v_and_b32 v185, 0xffff0000, v252
    v_lshlrev_b32 v186, 16, v253
    v_and_b32 v187, 0xffff0000, v253
    v_mfma_f32_32x32x16_bf16 v[144:159], a[140:143], a[248:251], v[144:159]
    v_lshlrev_b32 v188, 16, v254
    v_and_b32 v189, 0xffff0000, v254
    v_lshlrev_b32 v190, 16, v255
    v_and_b32 v191, 0xffff0000, v255
    v_mfma_f32_32x32x16_bf16 v[224:239], a[96:99], a[212:215], v[224:239]
    s_nop 5
    v_mfma_f32_32x32x16_bf16 v[224:239], a[104:107], a[220:223], v[224:239]
    s_nop 3
    ds_write_b128 v14, v[144:147] offset:32768
    v_mfma_f32_32x32x16_bf16 v[224:239], a[112:115], a[228:231], v[224:239]
    ds_write_b128 v15, v[148:151] offset:33792
    v_mfma_f32_32x32x16_bf16 v[224:239], a[120:123], a[236:239], v[224:239]
    ds_write_b128 v16, v[152:155] offset:34816
    v_mfma_f32_32x32x16_bf16 v[224:239], a[128:131], a[244:247], v[224:239]
    ds_write_b128 v17, v[156:159] offset:35840
    v_mfma_f32_32x32x16_bf16 v[224:239], a[136:139], a[252:255], v[224:239]
    v_mfma_f32_32x32x16_bf16 v[160:175], a[100:103], a[212:215], v[160:175]
    s_waitcnt lgkmcnt(0)
    s_barrier
    ds_read_b128 v[208:211], v19 offset:0
    ds_read_b128 v[212:215], v19 offset:512
    ds_read_b128 v[216:219], v19 offset:4096
    ds_read_b128 v[220:223], v19 offset:4608
    v_mfma_f32_32x32x16_bf16 v[160:175], a[108:111], a[220:223], v[160:175]
    ds_read_b128 v[144:147], v19 offset:8192
    ds_read_b128 v[148:151], v19 offset:8704
    ds_read_b128 v[152:155], v19 offset:12288
    ds_read_b128 v[156:159], v19 offset:12800
    v_mfma_f32_32x32x16_bf16 v[160:175], a[116:119], a[228:231], v[160:175]
    ds_write_b128 v14, v[224:227] offset:16384
    v_mfma_f32_32x32x16_bf16 v[160:175], a[124:127], a[236:239], v[160:175]
    s_waitcnt lgkmcnt(5)
    ds_write_b128 v15, v[228:231] offset:17408
    v_add_f32 v176, v176, v208
    v_add_f32 v177, v177, v209
    v_add_f32 v178, v178, v210
    v_add_f32 v179, v179, v211
    v_add_f32 v180, v180, v212
    v_mfma_f32_32x32x16_bf16 v[160:175], a[132:135], a[244:247], v[160:175]
    ds_write_b128 v16, v[232:235] offset:18432
    v_add_f32 v181, v181, v213
    v_add_f32 v182, v182, v214
    v_add_f32 v183, v183, v215
    v_add_f32 v176, v176, v216
    v_add_f32 v177, v177, v217
    v_mfma_f32_32x32x16_bf16 v[160:175], a[140:143], a[252:255], v[160:175]
    s_waitcnt lgkmcnt(3)
    ds_write_b128 v17, v[236:239] offset:19456
    v_add_f32 v178, v178, v218
    v_add_f32 v179, v179, v219
    v_add_f32 v180, v180, v220
    v_add_f32 v181, v181, v221
    v_add_f32 v182, v182, v222
    v_add_f32 v183, v183, v223
    v_add_f32 v176, v176, v144
    v_add_f32 v177, v177, v145
    v_add_f32 v178, v178, v146
    v_add_f32 v179, v179, v147
    v_add_f32 v180, v180, v148
    v_add_f32 v181, v181, v149
    ds_write_b128 v14, v[160:163] offset:49152
    ds_write_b128 v15, v[164:167] offset:50176
    ds_write_b128 v16, v[168:171] offset:51200
    ds_write_b128 v17, v[172:175] offset:52224
    v_add_f32 v182, v182, v150
    v_add_f32 v183, v183, v151
    v_add_f32 v176, v176, v152
    v_add_f32 v177, v177, v153
    v_add_f32 v178, v178, v154
    v_add_f32 v179, v179, v155
    v_add_f32 v180, v180, v156
    v_add_f32 v181, v181, v157
    v_add_f32 v182, v182, v158
    v_add_f32 v183, v183, v159
    v_cvt_pk_bf16_f32 v248, v176, v177
    v_cvt_pk_bf16_f32 v249, v178, v179
    v_cvt_pk_bf16_f32 v250, v180, v181
    v_cvt_pk_bf16_f32 v251, v182, v183
    buffer_store_dwordx4 v[248:251], v18, s[28:31], 0 offen offset:0 sc1
    s_waitcnt lgkmcnt(0)
    s_barrier
    ds_read_b128 v[32:35], v19 offset:16384
    ds_read_b128 v[36:39], v19 offset:16896
    ds_read_b128 v[40:43], v19 offset:20480
    ds_read_b128 v[44:47], v19 offset:20992
    ds_read_b128 v[48:51], v19 offset:24576
    ds_read_b128 v[52:55], v19 offset:25088
    ds_read_b128 v[56:59], v19 offset:28672
    ds_read_b128 v[60:63], v19 offset:29184
    s_waitcnt lgkmcnt(4)
    v_pk_add_f32 v[184:185], v[184:185], v[32:33]
    v_pk_add_f32 v[186:187], v[186:187], v[34:35]
    v_pk_add_f32 v[188:189], v[188:189], v[36:37]
    v_pk_add_f32 v[190:191], v[190:191], v[38:39]
    v_pk_add_f32 v[184:185], v[184:185], v[40:41]
    v_pk_add_f32 v[186:187], v[186:187], v[42:43]
    v_pk_add_f32 v[188:189], v[188:189], v[44:45]
    v_pk_add_f32 v[190:191], v[190:191], v[46:47]
    s_waitcnt lgkmcnt(0)
    v_pk_add_f32 v[184:185], v[184:185], v[48:49]
    v_pk_add_f32 v[186:187], v[186:187], v[50:51]
    v_pk_add_f32 v[188:189], v[188:189], v[52:53]
    v_pk_add_f32 v[190:191], v[190:191], v[54:55]
    v_pk_add_f32 v[184:185], v[184:185], v[56:57]
    v_pk_add_f32 v[186:187], v[186:187], v[58:59]
    v_pk_add_f32 v[188:189], v[188:189], v[60:61]
    v_pk_add_f32 v[190:191], v[190:191], v[62:63]
    v_cvt_pk_bf16_f32 v252, v184, v185
    v_cvt_pk_bf16_f32 v253, v186, v187
    v_cvt_pk_bf16_f32 v254, v188, v189
    v_cvt_pk_bf16_f32 v255, v190, v191
    buffer_store_dwordx4 v[252:255], v18, s[28:31], 0 offen offset:896 sc1
    s_endpgm
L_slow0:
    s_mov_b32 s72, 200000
L_spin0:
    s_load_dwordx4 s[44:47], s[24:25], s48 glc
    s_waitcnt lgkmcnt(0)
    s_or_b64 s[44:45], s[44:45], s[46:47]
    s_or_b32 s44, s44, s45
    s_and_b32 s44, s44, 16843009
    s_cbranch_scc0 L_back0
    s_sub_u32 s72, s72, 1
    s_cmp_lg_u32 s72, 0
    s_cbranch_scc1 L_spin0
    s_branch L_back0
L_slow1:
    s_mov_b32 s72, 200000
L_spin1:
    s_load_dwordx4 s[44:47], s[24:25], s48 glc
    s_waitcnt lgkmcnt(0)
    s_or_b64 s[44:45], s[44:45], s[46:47]
    s_or_b32 s44, s44, s45
    s_and_b32 s44, s44, 33686018
    s_cbranch_scc0 L_back1
    s_sub_u32 s72, s72, 1
    s_cmp_lg_u32 s72, 0
    s_cbranch_scc1 L_spin1
    s_branch L_back1
L_slow2:
    s_mov_b32 s72, 200000
L_spin2:
    s_load_dwordx4 s[44:47], s[24:25], s48 glc
    s_waitcnt lgkmcnt(0)
    s_or_b64 s[44:45], s[44:45], s[46:47]
    s_or_b32 s44, s44, s45
    s_and_b32 s44, s44, 67372036
    s_cbranch_scc0 L_back2
    s_sub_u32 s72, s72, 1
    s_cmp_lg_u32 s72, 0
    s_cbranch_scc1 L_spin2
    s_branch L_back2
L_slow3:
    s_mov_b32 s72, 200000
L_spin3:
    s_load_dwordx4 s[44:47], s[24:25], s48 glc
    s_waitcnt lgkmcnt(0)
    s_or_b64 s[44:45], s[44:45], s[46:47]
    s_or_b32 s44, s44, s45
    s_and_b32 s44, s44, 134744072
    s_cbranch_scc0 L_back3
    s_sub_u32 s72, s72, 1
    s_cmp_lg_u32 s72, 0
    s_cbranch_scc1 L_spin3
    s_branch L_back3
L_slow4:
    s_mov_b32 s72, 200000
L_spin4:
    s_load_dwordx2 s[44:45], s[24:25], s49 glc
    s_waitcnt lgkmcnt(0)
    s_or_b32 s44, s44, s45
    s_cbranch_scc0 L_back4
    s_sub_u32 s72, s72, 1
    s_cmp_lg_u32 s72, 0
    s_cbranch_scc1 L_spin4
    s_branch L_back4
L_slow5:
    s_mov_b32 s72, 200000
L_spin5:
    buffer_load_dword v0, v6, s[32:35], 0 offen sc1
    s_waitcnt vmcnt(0)
    v_cmp_ne_u32 vcc, 0x01010101, v0
    s_nop 1
    s_cbranch_vccz L_back5
    s_sub_u32 s72, s72, 1
    s_cmp_lg_u32 s72, 0
    s_cbranch_scc1 L_spin5
    s_branch L_back5
.p2align 12
L_bodyA:
L_stubA0:
    s_cbranch_execz L_retA
    s_mov_b64 s[32:33], s[64:65]
    s_mov_b32 s34, 256
    s_mov_b32 s35, 0x20000
    s_sub_u32 s5, s2, 228
    v_and_b32 v1, 31, v3
    v_lshrrev_b32 v2, 5, v3
    v_mov_b32 v12, 1
    v_min_u32 v13, 1, v3
    v_lshlrev_b32 v13, 30, v13
    v_lshlrev_b32 v20, 8, v0
    s_lshr_b32 s40, s4, 4
    s_mul_i32 s41, s40, 112
    s_add_u32 s41, s41, s4
    s_waitcnt vmcnt(8)
    buffer_store_byte v12, v20, s[32:35], s41 offen sc1
    s_mul_i32 s40, s40, 4336
    s_mul_i32 s36, s3, 8704
    s_add_u32 s36, s36, s4
    s_add_u32 s36, s36, s40
    s_add_u32 s36, s36, 1079296
    s_mul_i32 s40, s3, 112
    s_add_u32 s40, s40, 2
    v_and_b32 v4, 15, v3
    v_lshrrev_b32 v5, 4, v3
    v_mul_u32_u24 v14, 450, v4
    v_lshl_add_u32 v14, v5, 2, v14
    v_add_u32 v14, s40, v14
    v_and_b32 v18, 2, v14
    v_lshlrev_b32 v18, 3, v18
    v_and_b32 v14, -4, v14
    v_add_u32 v15, 16384, v14
    v_add_u32 v16, 32768, v14
    v_add_u32 v17, 49152, v14
    s_mul_i32 s40, s3, 458752
    s_lshl_b32 s41, s4, 9
    s_add_u32 s40, s40, s41
    s_add_u32 s40, s40, 4194304
    v_lshl_add_u32 v23, v4, 4, s40
    v_lshl_add_u32 v23, v5, 14, v23
    v_cvt_f32_u32 v11, v1
    v_cvt_f32_u32 v10, v2
    v_mul_f32 v10, 4.0, v10
    v_mul_f32 v4, 0x3d000000, v11
    v_mul_f32 v5, v10, v4
    v_fmamk_f32 v6, v4, 0x00000000, v5
    v_fmamk_f32 v7, v4, 0x3f800000, v5
    v_cos_f32 v8, v6
    v_cos_f32 v9, v7
    v_sin_f32 v6, v6
    v_sin_f32 v7, v7
    v_cvt_pk_bf16_f32 v8, v8, v9
    v_cvt_pk_bf16_f32 v6, v6, v7
    v_accvgpr_write_b32 a0, v8
    v_accvgpr_write_b32 a8, v6
    v_xor_b32 v6, 0x80008000, v6
    v_accvgpr_write_b32 a16, v6
    v_fmamk_f32 v6, v4, 0x40000000, v5
    v_fmamk_f32 v7, v4, 0x40400000, v5
    v_cos_f32 v8, v6
    v_cos_f32 v9, v7
    v_sin_f32 v6, v6
    v_sin_f32 v7, v7
    v_cvt_pk_bf16_f32 v8, v8, v9
    v_cvt_pk_bf16_f32 v6, v6, v7
    v_accvgpr_write_b32 a1, v8
    v_accvgpr_write_b32 a9, v6
    v_xor_b32 v6, 0x80008000, v6
    v_accvgpr_write_b32 a17, v6
    v_fmamk_f32 v6, v4, 0x41000000, v5
    v_fmamk_f32 v7, v4, 0x41100000, v5
    v_cos_f32 v8, v6
    v_cos_f32 v9, v7
    v_sin_f32 v6, v6
    v_sin_f32 v7, v7
    v_cvt_pk_bf16_f32 v8, v8, v9
    v_cvt_pk_bf16_f32 v6, v6, v7
    v_accvgpr_write_b32 a2, v8
    v_accvgpr_write_b32 a10, v6
    v_xor_b32 v6, 0x80008000, v6
    v_accvgpr_write_b32 a18, v6
    v_fmamk_f32 v6, v4, 0x41200000, v5
    v_fmamk_f32 v7, v4, 0x41300000, v5
    v_cos_f32 v8, v6
    v_cos_f32 v9, v7
    v_sin_f32 v6, v6
    v_sin_f32 v7, v7
    v_cvt_pk_bf16_f32 v8, v8, v9
    v_cvt_pk_bf16_f32 v6, v6, v7
    v_accvgpr_write_b32 a3, v8
    v_accvgpr_write_b32 a11, v6
    v_xor_b32 v6, 0x80008000, v6
    v_accvgpr_write_b32 a19, v6
    v_fmamk_f32 v6, v4, 0x41800000, v5
    v_fmamk_f32 v7, v4, 0x41880000, v5
    v_cos_f32 v8, v6
    v_cos_f32 v9, v7
    v_sin_f32 v6, v6
    v_sin_f32 v7, v7
    v_cvt_pk_bf16_f32 v8, v8, v9
    v_cvt_pk_bf16_f32 v6, v6, v7
    v_accvgpr_write_b32 a4, v8
    v_accvgpr_write_b32 a12, v6
    v_xor_b32 v6, 0x80008000, v6
    v_accvgpr_write_b32 a20, v6
    v_fmamk_f32 v6, v4, 0x41900000, v5
    v_fmamk_f32 v7, v4, 0x41980000, v5
    v_cos_f32 v8, v6
    v_cos_f32 v9, v7
    v_sin_f32 v6, v6
    v_sin_f32 v7, v7
    v_cvt_pk_bf16_f32 v8, v8, v9
    v_cvt_pk_bf16_f32 v6, v6, v7
    v_accvgpr_write_b32 a5, v8
    v_accvgpr_write_b32 a13, v6
    v_xor_b32 v6, 0x80008000, v6
    v_accvgpr_write_b32 a21, v6
    v_fmamk_f32 v6, v4, 0x41c00000, v5
    v_fmamk_f32 v7, v4, 0x41c80000, v5
    v_cos_f32 v8, v6
    v_cos_f32 v9, v7
    v_sin_f32 v6, v6
    v_sin_f32 v7, v7
    v_cvt_pk_bf16_f32 v8, v8, v9
    v_cvt_pk_bf16_f32 v6, v6, v7
    v_accvgpr_write_b32 a6, v8
    v_accvgpr_write_b32 a14, v6
    v_xor_b32 v6, 0x80008000, v6
    v_accvgpr_write_b32 a22, v6
    v_fmamk_f32 v6, v4, 0x41d00000, v5
    v_fmamk_f32 v7, v4, 0x41d80000, v5
    v_cos_f32 v8, v6
    v_cos_f32 v9, v7
    v_sin_f32 v6, v6
    v_sin_f32 v7, v7
    v_cvt_pk_bf16_f32 v8, v8, v9
    v_cvt_pk_bf16_f32 v6, v6, v7
    v_accvgpr_write_b32 a7, v8
    v_accvgpr_write_b32 a15, v6
    v_xor_b32 v6, 0x80008000, v6
    v_accvgpr_write_b32 a23, v6
    v_fmac_f32 v5, 0.5, v4
    v_fmamk_f32 v6, v4, 0x00000000, v5
    v_fmamk_f32 v7, v4, 0x3f800000, v5
    v_cos_f32 v8, v6
    v_cos_f32 v9, v7
    v_sin_f32 v6, v6
    v_sin_f32 v7, v7
    v_cvt_pk_bf16_f32 v8, v8, v9
    v_cvt_pk_bf16_f32 v6, v6, v7
    v_accvgpr_write_b32 a56, v8
    v_accvgpr_write_b32 a64, v6
    v_xor_b32 v6, 0x80008000, v6
    v_accvgpr_write_b32 a72, v6
    v_fmamk_f32 v6, v4, 0x40000000, v5
    v_fmamk_f32 v7, v4, 0x40400000, v5
    v_cos_f32 v8, v6
    v_cos_f32 v9, v7
    v_sin_f32 v6, v6
    v_sin_f32 v7, v7
    v_cvt_pk_bf16_f32 v8, v8, v9
    v_cvt_pk_bf16_f32 v6, v6, v7
    v_accvgpr_write_b32 a57, v8
    v_accvgpr_write_b32 a65, v6
    v_xor_b32 v6, 0x80008000, v6
    v_accvgpr_write_b32 a73, v6
    v_fmamk_f32 v6, v4, 0x41000000, v5
    v_fmamk_f32 v7, v4, 0x41100000, v5
    v_cos_f32 v8, v6
    v_cos_f32 v9, v7
    v_sin_f32 v6, v6
    v_sin_f32 v7, v7
    v_cvt_pk_bf16_f32 v8, v8, v9
    v_cvt_pk_bf16_f32 v6, v6, v7
    v_accvgpr_write_b32 a58, v8
    v_accvgpr_write_b32 a66, v6
    v_xor_b32 v6, 0x80008000, v6
    v_accvgpr_write_b32 a74, v6
    v_fmamk_f32 v6, v4, 0x41200000, v5
    v_fmamk_f32 v7, v4, 0x41300000, v5
    s_add_u32 m0, s42, 8192
    s_add_u32 s38, s38, 4096
    buffer_load_dwordx4 v19, s[12:15], s38 offen offset:0 lds
    v_cos_f32 v8, v6
    v_cos_f32 v9, v7
    v_sin_f32 v6, v6
    v_sin_f32 v7, v7
    v_cvt_pk_bf16_f32 v8, v8, v9
    v_cvt_pk_bf16_f32 v6, v6, v7
    v_accvgpr_write_b32 a59, v8
    v_accvgpr_write_b32 a67, v6
    v_xor_b32 v6, 0x80008000, v6
    v_accvgpr_write_b32 a75, v6
    v_fmamk_f32 v6, v4, 0x41800000, v5
    v_fmamk_f32 v7, v4, 0x41880000, v5
    v_cos_f32 v8, v6
    v_cos_f32 v9, v7
    v_sin_f32 v6, v6
    v_sin_f32 v7, v7
    buffer_load_dwordx4 v19, s[12:15], s38 offen offset:1024 lds
    v_cvt_pk_bf16_f32 v8, v8, v9
    v_cvt_pk_bf16_f32 v6, v6, v7
    v_accvgpr_write_b32 a60, v8
    v_accvgpr_write_b32 a68, v6
    v_xor_b32 v6, 0x80008000, v6
    v_accvgpr_write_b32 a76, v6
    v_fmamk_f32 v6, v4, 0x41900000, v5
    v_fmamk_f32 v7, v4, 0x41980000, v5
    v_cos_f32 v8, v6
    v_cos_f32 v9, v7
    v_sin_f32 v6, v6
    v_sin_f32 v7, v7
    v_cvt_pk_bf16_f32 v8, v8, v9
    v_cvt_pk_bf16_f32 v6, v6, v7
    v_accvgpr_write_b32 a61, v8
    v_accvgpr_write_b32 a69, v6
    v_xor_b32 v6, 0x80008000, v6
    v_accvgpr_write_b32 a77, v6
    v_fmamk_f32 v6, v4, 0x41c00000, v5
    v_fmamk_f32 v7, v4, 0x41c80000, v5
    buffer_load_dwordx4 v19, s[12:15], s38 offen offset:2048 lds
    v_cos_f32 v8, v6
    v_cos_f32 v9, v7
    v_sin_f32 v6, v6
    v_sin_f32 v7, v7
    v_cvt_pk_bf16_f32 v8, v8, v9
    v_cvt_pk_bf16_f32 v6, v6, v7
    v_accvgpr_write_b32 a62, v8
    v_accvgpr_write_b32 a70, v6
    v_xor_b32 v6, 0x80008000, v6
    v_accvgpr_write_b32 a78, v6
    v_fmamk_f32 v6, v4, 0x41d00000, v5
    v_fmamk_f32 v7, v4, 0x41d80000, v5
    v_cos_f32 v8, v6
    v_cos_f32 v9, v7
    v_sin_f32 v6, v6
    v_sin_f32 v7, v7
    buffer_load_dwordx4 v19, s[12:15], s38 offen offset:3072 lds
    v_cvt_pk_bf16_f32 v8, v8, v9
    v_cvt_pk_bf16_f32 v6, v6, v7
    v_accvgpr_write_b32 a63, v8
    v_accvgpr_write_b32 a71, v6
    v_xor_b32 v6, 0x80008000, v6
    v_accvgpr_write_b32 a79, v6
    v_add_f32 v4, 0x3c800000, v4
    v_mul_f32 v5, v10, v4
    v_fmamk_f32 v6, v4, 0x00000000, v5
    v_fmamk_f32 v7, v4, 0x3f800000, v5
    v_cos_f32 v8, v6
    v_cos_f32 v9, v7
    v_sin_f32 v6, v6
    v_sin_f32 v7, v7
    v_cvt_pk_bf16_f32 v8, v8, v9
    v_cvt_pk_bf16_f32 v6, v6, v7
    v_accvgpr_write_b32 a24, v8
    v_accvgpr_write_b32 a40, v6
    v_xor_b32 v6, 0x80008000, v6
    v_accvgpr_write_b32 a48, v6
    s_add_u32 m0, s42, 12288
    s_add_u32 s38, s38, 4096
    buffer_load_dwordx4 v19, s[12:15], s38 offen offset:0 lds
    v_xor_b32 v8, 0x80008000, v8
    v_accvgpr_write_b32 a32, v8
    v_fmamk_f32 v6, v4, 0x40000000, v5
    v_fmamk_f32 v7, v4, 0x40400000, v5
    v_cos_f32 v8, v6
    v_cos_f32 v9, v7
    v_sin_f32 v6, v6
    v_sin_f32 v7, v7
    v_cvt_pk_bf16_f32 v8, v8, v9
    v_cvt_pk_bf16_f32 v6, v6, v7
    v_accvgpr_write_b32 a25, v8
    v_accvgpr_write_b32 a41, v6
    v_xor_b32 v6, 0x80008000, v6
    v_accvgpr_write_b32 a49, v6
    v_xor_b32 v8, 0x80008000, v8
    v_accvgpr_write_b32 a33, v8
    v_fmamk_f32 v6, v4, 0x41000000, v5
    v_fmamk_f32 v7, v4, 0x41100000, v5
    v_cos_f32 v8, v6
    buffer_load_dwordx4 v19, s[12:15], s38 offen offset:1024 lds
    v_cos_f32 v9, v7
    v_sin_f32 v6, v6
    v_sin_f32 v7, v7
    v_cvt_pk_bf16_f32 v8, v8, v9
    v_cvt_pk_bf16_f32 v6, v6, v7
    v_accvgpr_write_b32 a26, v8
    v_accvgpr_write_b32 a42, v6
    v_xor_b32 v6, 0x80008000, v6
    v_accvgpr_write_b32 a50, v6
    v_xor_b32 v8, 0x80008000, v8
    v_accvgpr_write_b32 a34, v8
    v_fmamk_f32 v6, v4, 0x41200000, v5
    v_fmamk_f32 v7, v4, 0x41300000, v5
    v_cos_f32 v8, v6
    v_cos_f32 v9, v7
    v_sin_f32 v6, v6
    v_sin_f32 v7, v7
    buffer_load_dwordx4 v19, s[12:15], s38 offen offset:2048 lds
    v_cvt_pk_bf16_f32 v8, v8, v9
    v_cvt_pk_bf16_f32 v6, v6, v7
    v_accvgpr_write_b32 a27, v8
    v_accvgpr_write_b32 a43, v6
    v_xor_b32 v6, 0x80008000, v6
    v_accvgpr_write_b32 a51, v6
    v_xor_b32 v8, 0x80008000, v8
    v_accvgpr_write_b32 a35, v8
    v_fmamk_f32 v6, v4, 0x41800000, v5
    v_fmamk_f32 v7, v4, 0x41880000, v5
    v_cos_f32 v8, v6
    v_cos_f32 v9, v7
    s_waitcnt vmcnt(8)
    s_barrier
    ds_read2_b32 v[32:33], v14 offset0:0 offset1:1
    ds_read2_b32 v[34:35], v15 offset0:0 offset1:1
    ds_read2_b32 v[36:37], v16 offset0:0 offset1:1
    ds_read2_b32 v[38:39], v17 offset0:0 offset1:1
    ds_read2_b32 v[40:41], v14 offset0:4 offset1:5
    ds_read2_b32 v[42:43], v15 offset0:4 offset1:5
    ds_read2_b32 v[44:45], v16 offset0:4 offset1:5
    ds_read2_b32 v[46:47], v17 offset0:4 offset1:5
    ds_read2_b32 v[48:49], v14 offset0:8 offset1:9
    ds_read2_b32 v[50:51], v15 offset0:8 offset1:9
    ds_read2_b32 v[52:53], v16 offset0:8 offset1:9
    ds_read2_b32 v[54:55], v17 offset0:8 offset1:9
    s_waitcnt lgkmcnt(11)
    v_alignbit_b32 v32, v33, v32, v18
    s_waitcnt lgkmcnt(10)
    v_alignbit_b32 v33, v35, v34, v18
    s_waitcnt lgkmcnt(9)
    v_alignbit_b32 v34, v37, v36, v18
    s_waitcnt lgkmcnt(8)
    v_alignbit_b32 v35, v39, v38, v18
    s_mov_b32 s40, 0
    buffer_store_dwordx4 v[32:35], v23, s[24:27], s40 offen offset:0 sc1
    ds_read2_b32 v[56:57], v14 offset0:12 offset1:13
    ds_read2_b32 v[58:59], v15 offset0:12 offset1:13
    ds_read2_b32 v[60:61], v16 offset0:12 offset1:13
    ds_read2_b32 v[62:63], v17 offset0:12 offset1:13
    s_waitcnt lgkmcnt(11)
    v_alignbit_b32 v40, v41, v40, v18
    s_waitcnt lgkmcnt(10)
    v_alignbit_b32 v41, v43, v42, v18
    s_waitcnt lgkmcnt(9)
    v_alignbit_b32 v42, v45, v44, v18
    s_waitcnt lgkmcnt(8)
    v_alignbit_b32 v43, v47, v46, v18
    s_mov_b32 s40, 65536
    buffer_store_dwordx4 v[40:43], v23, s[24:27], s40 offen offset:0 sc1
    ds_read2_b32 v[64:65], v14 offset0:16 offset1:17
    ds_read2_b32 v[66:67], v15 offset0:16 offset1:17
    ds_read2_b32 v[68:69], v16 offset0:16 offset1:17
    ds_read2_b32 v[70:71], v17 offset0:16 offset1:17
    s_waitcnt lgkmcnt(11)
    v_alignbit_b32 v48, v49, v48, v18
    s_waitcnt lgkmcnt(10)
    v_alignbit_b32 v49, v51, v50, v18
    s_waitcnt lgkmcnt(9)
    v_alignbit_b32 v50, v53, v52, v18
    s_waitcnt lgkmcnt(8)
    v_alignbit_b32 v51, v55, v54, v18
    s_mov_b32 s40, 131072
    buffer_store_dwordx4 v[48:51], v23, s[24:27], s40 offen offset:0 sc1
    ds_read2_b32 v[72:73], v14 offset0:20 offset1:21
    ds_read2_b32 v[74:75], v15 offset0:20 offset1:21
    ds_read2_b32 v[76:77], v16 offset0:20 offset1:21
    ds_read2_b32 v[78:79], v17 offset0:20 offset1:21
    s_waitcnt lgkmcnt(11)
    v_alignbit_b32 v56, v57, v56, v18
    s_waitcnt lgkmcnt(10)
    v_alignbit_b32 v57, v59, v58, v18
    s_waitcnt lgkmcnt(9)
    v_alignbit_b32 v58, v61, v60, v18
    s_waitcnt lgkmcnt(8)
    v_alignbit_b32 v59, v63, v62, v18
    s_mov_b32 s40, 196608
    buffer_store_dwordx4 v[56:59], v23, s[24:27], s40 offen offset:0 sc1
    ds_read2_b32 v[80:81], v14 offset0:24 offset1:25
    ds_read2_b32 v[82:83], v15 offset0:24 offset1:25
    ds_read2_b32 v[84:85], v16 offset0:24 offset1:25
    ds_read2_b32 v[86:87], v17 offset0:24 offset1:25
    s_waitcnt lgkmcnt(11)
    v_alignbit_b32 v64, v65, v64, v18
    s_waitcnt lgkmcnt(10)
    v_alignbit_b32 v65, v67, v66, v18
    s_waitcnt lgkmcnt(9)
    v_alignbit_b32 v66, v69, v68, v18
    s_waitcnt lgkmcnt(8)
    v_alignbit_b32 v67, v71, v70, v18
    s_mov_b32 s40, 262144
    buffer_store_dwordx4 v[64:67], v23, s[24:27], s40 offen offset:0 sc1
    s_waitcnt lgkmcnt(7)
    v_alignbit_b32 v72, v73, v72, v18
    s_waitcnt lgkmcnt(6)
    v_alignbit_b32 v73, v75, v74, v18
    s_waitcnt lgkmcnt(5)
    v_alignbit_b32 v74, v77, v76, v18
    s_waitcnt lgkmcnt(4)
    v_alignbit_b32 v75, v79, v78, v18
    s_mov_b32 s40, 327680
    buffer_store_dwordx4 v[72:75], v23, s[24:27], s40 offen offset:0 sc1
    s_waitcnt lgkmcnt(3)
    v_alignbit_b32 v80, v81, v80, v18
    s_waitcnt lgkmcnt(2)
    v_alignbit_b32 v81, v83, v82, v18
    s_waitcnt lgkmcnt(1)
    v_alignbit_b32 v82, v85, v84, v18
    s_waitcnt lgkmcnt(0)
    v_alignbit_b32 v83, v87, v86, v18
    s_mov_b32 s40, 393216
    buffer_store_dwordx4 v[80:83], v23, s[24:27], s40 offen offset:0 sc1
    v_add_u32 v14, 7200, v14
    v_add_u32 v15, 7200, v15
    v_add_u32 v16, 7200, v16
    v_add_u32 v17, 7200, v17
    s_waitcnt vmcnt(7)
    s_barrier
    ds_read2_b32 v[88:89], v14 offset0:0 offset1:1
    ds_read2_b32 v[90:91], v15 offset0:0 offset1:1
    ds_read2_b32 v[92:93], v16 offset0:0 offset1:1
    ds_read2_b32 v[94:95], v17 offset0:0 offset1:1
    ds_read2_b32 v[96:97], v14 offset0:4 offset1:5
    ds_read2_b32 v[98:99], v15 offset0:4 offset1:5
    ds_read2_b32 v[100:101], v16 offset0:4 offset1:5
    ds_read2_b32 v[102:103], v17 offset0:4 offset1:5
    ds_read2_b32 v[104:105], v14 offset0:8 offset1:9
    ds_read2_b32 v[106:107], v15 offset0:8 offset1:9
    ds_read2_b32 v[108:109], v16 offset0:8 offset1:9
    ds_read2_b32 v[110:111], v17 offset0:8 offset1:9
    s_waitcnt lgkmcnt(11)
    v_alignbit_b32 v88, v89, v88, v18
    s_waitcnt lgkmcnt(10)
    v_alignbit_b32 v89, v91, v90, v18
    s_waitcnt lgkmcnt(9)
    v_alignbit_b32 v90, v93, v92, v18
    s_waitcnt lgkmcnt(8)
    v_alignbit_b32 v91, v95, v94, v18
    s_mov_b32 s40, 0
    buffer_store_dwordx4 v[88:91], v23, s[24:27], s40 offen offset:256 sc1
    ds_read2_b32 v[112:113], v14 offset0:12 offset1:13
    ds_read2_b32 v[114:115], v15 offset0:12 offset1:13
    ds_read2_b32 v[116:117], v16 offset0:12 offset1:13
    ds_read2_b32 v[118:119], v17 offset0:12 offset1:13
    s_waitcnt lgkmcnt(11)
    v_alignbit_b32 v96, v97, v96, v18
    s_waitcnt lgkmcnt(10)
    v_alignbit_b32 v97, v99, v98, v18
    s_waitcnt lgkmcnt(9)
    v_alignbit_b32 v98, v101, v100, v18
    s_waitcnt lgkmcnt(8)
    v_alignbit_b32 v99, v103, v102, v18
    s_mov_b32 s40, 65536
    buffer_store_dwordx4 v[96:99], v23, s[24:27], s40 offen offset:256 sc1
    ds_read2_b32 v[120:121], v14 offset0:16 offset1:17
    ds_read2_b32 v[122:123], v15 offset0:16 offset1:17
    ds_read2_b32 v[124:125], v16 offset0:16 offset1:17
    ds_read2_b32 v[126:127], v17 offset0:16 offset1:17
    s_waitcnt lgkmcnt(11)
    v_alignbit_b32 v104, v105, v104, v18
    s_waitcnt lgkmcnt(10)
    v_alignbit_b32 v105, v107, v106, v18
    s_waitcnt lgkmcnt(9)
    v_alignbit_b32 v106, v109, v108, v18
    s_waitcnt lgkmcnt(8)
    v_alignbit_b32 v107, v111, v110, v18
    s_mov_b32 s40, 131072
    buffer_store_dwordx4 v[104:107], v23, s[24:27], s40 offen offset:256 sc1
    ds_read2_b32 v[128:129], v14 offset0:20 offset1:21
    ds_read2_b32 v[130:131], v15 offset0:20 offset1:21
    ds_read2_b32 v[132:133], v16 offset0:20 offset1:21
    ds_read2_b32 v[134:135], v17 offset0:20 offset1:21
    s_waitcnt lgkmcnt(11)
    v_alignbit_b32 v112, v113, v112, v18
    s_waitcnt lgkmcnt(10)
    v_alignbit_b32 v113, v115, v114, v18
    s_waitcnt lgkmcnt(9)
    v_alignbit_b32 v114, v117, v116, v18
    s_waitcnt lgkmcnt(8)
    v_alignbit_b32 v115, v119, v118, v18
    s_mov_b32 s40, 196608
    buffer_store_dwordx4 v[112:115], v23, s[24:27], s40 offen offset:256 sc1
    ds_read2_b32 v[136:137], v14 offset0:24 offset1:25
    ds_read2_b32 v[138:139], v15 offset0:24 offset1:25
    ds_read2_b32 v[140:141], v16 offset0:24 offset1:25
    ds_read2_b32 v[142:143], v17 offset0:24 offset1:25
    s_waitcnt lgkmcnt(11)
    v_alignbit_b32 v120, v121, v120, v18
    s_waitcnt lgkmcnt(10)
    v_alignbit_b32 v121, v123, v122, v18
    s_waitcnt lgkmcnt(9)
    v_alignbit_b32 v122, v125, v124, v18
    s_waitcnt lgkmcnt(8)
    v_alignbit_b32 v123, v127, v126, v18
    s_mov_b32 s40, 262144
    buffer_store_dwordx4 v[120:123], v23, s[24:27], s40 offen offset:256 sc1
    s_waitcnt lgkmcnt(7)
    v_alignbit_b32 v128, v129, v128, v18
    s_waitcnt lgkmcnt(6)
    v_alignbit_b32 v129, v131, v130, v18
    s_waitcnt lgkmcnt(5)
    v_alignbit_b32 v130, v133, v132, v18
    s_waitcnt lgkmcnt(4)
    v_alignbit_b32 v131, v135, v134, v18
    s_mov_b32 s40, 327680
    buffer_store_dwordx4 v[128:131], v23, s[24:27], s40 offen offset:256 sc1
    s_waitcnt lgkmcnt(3)
    v_alignbit_b32 v136, v137, v136, v18
    s_waitcnt lgkmcnt(2)
    v_alignbit_b32 v137, v139, v138, v18
    s_waitcnt lgkmcnt(1)
    v_alignbit_b32 v138, v141, v140, v18
    s_waitcnt lgkmcnt(0)
    v_alignbit_b32 v139, v143, v142, v18
    s_mov_b32 s40, 393216
    buffer_store_dwordx4 v[136:139], v23, s[24:27], s40 offen offset:256 sc1
    v_and_b32 v21, 12, v3
    v_and_b32 v20, 16, v3
    v_lshl_add_u32 v21, v20, 3, v21
    buffer_load_dword v20, v21, s[32:35], 0 offen sc1
    v_sin_f32 v6, v6
    v_sin_f32 v7, v7
    v_cvt_pk_bf16_f32 v8, v8, v9
    v_cvt_pk_bf16_f32 v6, v6, v7
    v_accvgpr_write_b32 a28, v8
    v_accvgpr_write_b32 a44, v6
    v_xor_b32 v6, 0x80008000, v6
    v_accvgpr_write_b32 a52, v6
    v_xor_b32 v8, 0x80008000, v8
    v_accvgpr_write_b32 a36, v8
    v_fmamk_f32 v6, v4, 0x41900000, v5
    v_fmamk_f32 v7, v4, 0x41980000, v5
    v_cos_f32 v8, v6
    v_cos_f32 v9, v7
    v_sin_f32 v6, v6
    v_sin_f32 v7, v7
    v_cvt_pk_bf16_f32 v8, v8, v9
    v_cvt_pk_bf16_f32 v6, v6, v7
    v_accvgpr_write_b32 a29, v8
    v_accvgpr_write_b32 a45, v6
    v_xor_b32 v6, 0x80008000, v6
    v_accvgpr_write_b32 a53, v6
    v_xor_b32 v8, 0x80008000, v8
    v_accvgpr_write_b32 a37, v8
    v_fmamk_f32 v6, v4, 0x41c00000, v5
    v_fmamk_f32 v7, v4, 0x41c80000, v5
    v_cos_f32 v8, v6
    v_cos_f32 v9, v7
    v_sin_f32 v6, v6
    v_sin_f32 v7, v7
    v_cvt_pk_bf16_f32 v8, v8, v9
    v_cvt_pk_bf16_f32 v6, v6, v7
    v_accvgpr_write_b32 a30, v8
    v_accvgpr_write_b32 a46, v6
    v_xor_b32 v6, 0x80008000, v6
    v_accvgpr_write_b32 a54, v6
    v_xor_b32 v8, 0x80008000, v8
    v_accvgpr_write_b32 a38, v8
    v_fmamk_f32 v6, v4, 0x41d00000, v5
    v_fmamk_f32 v7, v4, 0x41d80000, v5
    v_cos_f32 v8, v6
    v_cos_f32 v9, v7
    v_sin_f32 v6, v6
    v_sin_f32 v7, v7
    v_cvt_pk_bf16_f32 v8, v8, v9
    v_cvt_pk_bf16_f32 v6, v6, v7
    v_accvgpr_write_b32 a31, v8
    v_accvgpr_write_b32 a47, v6
    v_xor_b32 v6, 0x80008000, v6
    v_accvgpr_write_b32 a55, v6
    v_xor_b32 v8, 0x80008000, v8
    v_accvgpr_write_b32 a39, v8
    s_lshl_b32 s40, s3, 3
    v_lshl_add_u32 v5, v2, 2, s40
    v_cvt_f32_u32 v5, v5
    v_add_u32 v22, 131072, v19
    s_lshl_b32 s40, s3, 11
    v_add_u32 v6, s40, v22
    v_add_f32 v4, 0x00000000, v11
    v_mul_f32 v4, 0x3a000000, v4
    v_mul_f32 v224, v5, v4
    v_fmamk_f32 v225, v4, 0x3f800000, v224
    v_fmamk_f32 v226, v4, 0x40000000, v224
    v_fmamk_f32 v227, v4, 0x40400000, v224
    v_sin_f32 v228, v224
    v_sin_f32 v229, v225
    v_sin_f32 v230, v226
    v_sin_f32 v231, v227
    v_cos_f32 v224, v224
    v_cos_f32 v225, v225
    v_cos_f32 v226, v226
    v_cos_f32 v227, v227
    v_mul_f32 v228, 0x36124925, v228
    v_mul_f32 v229, 0x36124925, v229
    v_mul_f32 v230, 0x36124925, v230
    v_mul_f32 v231, 0x36124925, v231
    v_mul_f32 v224, 0x36124925, v224
    v_mul_f32 v225, 0x36124925, v225
    v_mul_f32 v226, 0x36124925, v226
    v_mul_f32 v227, 0x36124925, v227
    ds_write_b128 v6, v[224:227] offset:0
    ds_write_b128 v6, v[228:231] offset:1024
    v_add_f32 v4, 0x42000000, v11
    v_mul_f32 v4, 0x3a000000, v4
    v_mul_f32 v224, v5, v4
    v_fmamk_f32 v225, v4, 0x3f800000, v224
    v_fmamk_f32 v226, v4, 0x40000000, v224
    v_fmamk_f32 v227, v4, 0x40400000, v224
    v_sin_f32 v228, v224
    v_sin_f32 v229, v225
    v_sin_f32 v230, v226
    v_sin_f32 v231, v227
    v_cos_f32 v224, v224
    v_cos_f32 v225, v225
    v_cos_f32 v226, v226
    v_cos_f32 v227, v227
    v_mul_f32 v228, 0x36124925, v228
    v_mul_f32 v229, 0x36124925, v229
    v_mul_f32 v230, 0x36124925, v230
L_stubA1:
    s_cbranch_execz L_retA
    v_mul_f32 v231, 0x36124925, v231
    v_mul_f32 v224, 0x36124925, v224
    v_mul_f32 v225, 0x36124925, v225
    v_mul_f32 v226, 0x36124925, v226
    v_mul_f32 v227, 0x36124925, v227
    ds_write_b128 v6, v[224:227] offset:8192
    ds_write_b128 v6, v[228:231] offset:9216
    s_waitcnt vmcnt(0)
    v_cmp_ne_u32 vcc, 0x01010101, v20
    s_nop 0
    s_cbranch_vccnz L_slow6
L_back6:
    v_mov_b32 v12, 0
    buffer_store_byte v12, v13, s[24:27], s36 offen sc1
    s_cmp_lt_u32 s4, 4
    s_cbranch_scc1 L_Aend
    s_mul_i32 s6, s5, 37
    s_lshr_b32 s6, s6, 8
    s_lshl_b32 s49, s6, 1
    s_add_u32 s49, s49, s3
    s_mul_i32 s49, s49, 4352
    s_add_u32 s49, s49, 1079296
    s_mul_i32 s36, s6, 4345
    s_add_u32 s36, s36, s5
    s_add_u32 s36, s36, 278528
    v_lshrrev_b32 v4, 5, v0
    v_mul_u32_u24 v13, 17408, v1
    v_lshl_add_u32 v13, v4, 28, v13
    v_bfe_u32 v4, v3, 2, 2
    v_bfe_u32 v5, v3, 4, 1
    v_lshl_add_u32 v5, v4, 1, v5
    v_lshlrev_b32 v14, 8, v5
    v_lshl_add_u32 v14, v2, 11, v14
    v_and_b32 v6, 1, v3
    v_lshl_add_u32 v14, v6, 7, v14
    s_lshl_b32 s40, s3, 1
    v_xor_b32 v5, s40, v5
    v_lshl_add_u32 v14, v5, 4, v14
    v_bfe_u32 v4, v3, 1, 1
    v_lshl_add_u32 v14, v4, 3, v14
    v_add_u32 v14, 65536, v14
    v_xor_b32 v15, 16, v14
    s_lshl_b32 s40, s5, 2
    s_add_u32 s40, s40, s3
    s_lshl_b32 s41, s40, 14
    s_add_u32 s41, s41, 4194304
    v_lshl_add_u32 v18, v1, 4, s41
    v_lshl_add_u32 v18, v2, 11, v18
    s_lshl_b32 s41, s40, 9
    s_add_u32 s41, s41, 6291456
    v_lshl_add_u32 v23, v1, 4, s41
    v_mul_u32_u24 v4, 114688, v2
    v_add_u32 v23, v23, v4
    s_mov_b32 s37, s40
    s_lshr_b32 s48, s5, 1
    s_lshl_b32 s48, s48, 2
    s_add_u32 s48, s48, s3
    s_mul_i32 s48, s48, 4352
    s_add_u32 s48, s48, 835584
    s_lshl_b32 s40, s5, 16
    s_lshl_b32 s41, s3, 13
    s_add_u32 s40, s40, s41
    s_add_u32 s40, s40, 2097152
    s_add_u32 s41, s41, 65536
    s_waitcnt lgkmcnt(0)
    s_cmp_ge_u32 s3, 2
    s_cbranch_scc1 L_nowp
    s_load_dwordx4 s[44:47], s[24:25], s49 glc
    s_waitcnt lgkmcnt(0)
    s_or_b64 s[44:45], s[44:45], s[46:47]
    s_or_b32 s44, s44, s45
    s_cbranch_scc1 L_slow7
L_back7:
L_nowp:
    s_barrier
    buffer_load_dwordx4 v[160:163], v18, s[24:27], 0 offen offset:0 sc1
    buffer_load_dwordx4 v[164:167], v18, s[24:27], 0 offen offset:512 sc1
    buffer_load_dwordx4 v[168:171], v18, s[24:27], 0 offen offset:1024 sc1
    buffer_load_dwordx4 v[172:175], v18, s[24:27], 0 offen offset:1536 sc1
    v_add_u32 v18, 4096, v18
    buffer_load_dwordx4 v[176:179], v18, s[24:27], 0 offen offset:0 sc1
    buffer_load_dwordx4 v[180:183], v18, s[24:27], 0 offen offset:512 sc1
    buffer_load_dwordx4 v[184:187], v18, s[24:27], 0 offen offset:1024 sc1
    buffer_load_dwordx4 v[188:191], v18, s[24:27], 0 offen offset:1536 sc1
    s_load_dwordx4 s[44:47], s[24:25], s48 glc
    v_add_u32 v18, 4096, v18
    buffer_load_dwordx4 v[192:195], v18, s[24:27], 0 offen offset:0 sc1
    buffer_load_dwordx4 v[196:199], v18, s[24:27], 0 offen offset:512 sc1
    buffer_load_dwordx4 v[200:203], v18, s[24:27], 0 offen offset:1024 sc1
    buffer_load_dwordx4 v[204:207], v18, s[24:27], 0 offen offset:1536 sc1
    v_add_u32 v18, 4096, v18
    buffer_load_dwordx4 v[208:211], v18, s[24:27], 0 offen offset:0 sc1
    buffer_load_dwordx4 v[212:215], v18, s[24:27], 0 offen offset:512 sc1
    buffer_load_dwordx4 v[216:219], v18, s[24:27], 0 offen offset:1024 sc1
    buffer_load_dwordx4 v[220:223], v18, s[24:27], 0 offen offset:1536 sc1
    s_waitcnt lgkmcnt(0)
    s_or_b64 s[44:45], s[44:45], s[46:47]
    s_or_b32 s44, s44, s45
    s_cbranch_scc1 L_slow8
L_back8:
    s_add_u32 m0, s41, 0
    s_add_u32 s38, s40, 0
    buffer_load_dwordx4 v19, s[24:27], s38 offen offset:0 sc1 lds
    buffer_load_dwordx4 v19, s[24:27], s38 offen offset:1024 sc1 lds
    buffer_load_dwordx4 v19, s[24:27], s38 offen offset:2048 sc1 lds
    buffer_load_dwordx4 v19, s[24:27], s38 offen offset:3072 sc1 lds
    s_waitcnt vmcnt(19)
    v_lshlrev_b32 v32, 16, v160
    v_and_b32 v96, 0xffff0000, v160
    v_lshlrev_b32 v48, 16, v161
    v_and_b32 v112, 0xffff0000, v161
    v_lshlrev_b32 v64, 16, v162
    v_and_b32 v128, 0xffff0000, v162
    v_lshlrev_b32 v80, 16, v163
    v_and_b32 v144, 0xffff0000, v163
    s_waitcnt vmcnt(18)
    v_lshlrev_b32 v33, 16, v164
    v_and_b32 v97, 0xffff0000, v164
    v_lshlrev_b32 v49, 16, v165
    v_and_b32 v113, 0xffff0000, v165
    v_lshlrev_b32 v65, 16, v166
    v_and_b32 v129, 0xffff0000, v166
    s_add_u32 m0, s41, 4096
    s_add_u32 s38, s40, 4096
    buffer_load_dwordx4 v19, s[24:27], s38 offen offset:0 sc1 lds
    v_lshlrev_b32 v81, 16, v167
    v_and_b32 v145, 0xffff0000, v167
    s_waitcnt vmcnt(18)
    v_lshlrev_b32 v34, 16, v168
    v_and_b32 v98, 0xffff0000, v168
    v_lshlrev_b32 v50, 16, v169
    v_and_b32 v114, 0xffff0000, v169
    v_lshlrev_b32 v66, 16, v170
    v_and_b32 v130, 0xffff0000, v170
    v_lshlrev_b32 v82, 16, v171
    v_and_b32 v146, 0xffff0000, v171
    s_waitcnt vmcnt(17)
    v_lshlrev_b32 v35, 16, v172
    v_and_b32 v99, 0xffff0000, v172
    v_lshlrev_b32 v51, 16, v173
    v_and_b32 v115, 0xffff0000, v173
    buffer_load_dwordx4 v19, s[24:27], s38 offen offset:1024 sc1 lds
    v_lshlrev_b32 v67, 16, v174
    v_and_b32 v131, 0xffff0000, v174
    v_lshlrev_b32 v83, 16, v175
    v_and_b32 v147, 0xffff0000, v175
    s_waitcnt vmcnt(17)
    v_lshlrev_b32 v36, 16, v176
    v_and_b32 v100, 0xffff0000, v176
    v_lshlrev_b32 v52, 16, v177
    v_and_b32 v116, 0xffff0000, v177
    v_lshlrev_b32 v68, 16, v178
    v_and_b32 v132, 0xffff0000, v178
    v_lshlrev_b32 v84, 16, v179
    v_and_b32 v148, 0xffff0000, v179
    s_waitcnt vmcnt(16)
    v_lshlrev_b32 v37, 16, v180
    v_and_b32 v101, 0xffff0000, v180
    buffer_load_dwordx4 v19, s[24:27], s38 offen offset:2048 sc1 lds
    v_lshlrev_b32 v53, 16, v181
    v_and_b32 v117, 0xffff0000, v181
    v_lshlrev_b32 v69, 16, v182
    v_and_b32 v133, 0xffff0000, v182
    v_lshlrev_b32 v85, 16, v183
    v_and_b32 v149, 0xffff0000, v183
    s_waitcnt vmcnt(16)
    v_lshlrev_b32 v38, 16, v184
    v_and_b32 v102, 0xffff0000, v184
    v_lshlrev_b32 v54, 16, v185
    v_and_b32 v118, 0xffff0000, v185
    v_lshlrev_b32 v70, 16, v186
    v_and_b32 v134, 0xffff0000, v186
    v_lshlrev_b32 v86, 16, v187
    v_and_b32 v150, 0xffff0000, v187
    buffer_load_dwordx4 v19, s[24:27], s38 offen offset:3072 sc1 lds
    s_waitcnt vmcnt(16)
    v_lshlrev_b32 v39, 16, v188
    v_and_b32 v103, 0xffff0000, v188
    v_lshlrev_b32 v55, 16, v189
    v_and_b32 v119, 0xffff0000, v189
    v_lshlrev_b32 v71, 16, v190
    v_and_b32 v135, 0xffff0000, v190
    v_lshlrev_b32 v87, 16, v191
    v_and_b32 v151, 0xffff0000, v191
    s_waitcnt vmcnt(15)
    v_lshlrev_b32 v40, 16, v192
    v_and_b32 v104, 0xffff0000, v192
    v_lshlrev_b32 v56, 16, v193
    v_and_b32 v120, 0xffff0000, v193
    v_lshlrev_b32 v72, 16, v194
    v_and_b32 v136, 0xffff0000, v194
    s_add_u32 m0, s41, 32768
    s_add_u32 s38, s40, 32768
    buffer_load_dwordx4 v19, s[24:27], s38 offen offset:0 sc1 lds
    v_lshlrev_b32 v88, 16, v195
    v_and_b32 v152, 0xffff0000, v195
    s_waitcnt vmcnt(15)
    v_lshlrev_b32 v41, 16, v196
    v_and_b32 v105, 0xffff0000, v196
    v_lshlrev_b32 v57, 16, v197
    v_and_b32 v121, 0xffff0000, v197
    v_lshlrev_b32 v73, 16, v198
    v_and_b32 v137, 0xffff0000, v198
    v_lshlrev_b32 v89, 16, v199
    v_and_b32 v153, 0xffff0000, v199
    s_waitcnt vmcnt(14)
    v_lshlrev_b32 v42, 16, v200
    v_and_b32 v106, 0xffff0000, v200
    v_lshlrev_b32 v58, 16, v201
    v_and_b32 v122, 0xffff0000, v201
    buffer_load_dwordx4 v19, s[24:27], s38 offen offset:1024 sc1 lds
    v_lshlrev_b32 v74, 16, v202
    v_and_b32 v138, 0xffff0000, v202
    v_lshlrev_b32 v90, 16, v203
    v_and_b32 v154, 0xffff0000, v203
    s_waitcnt vmcnt(14)
    v_lshlrev_b32 v43, 16, v204
    v_and_b32 v107, 0xffff0000, v204
    v_lshlrev_b32 v59, 16, v205
    v_and_b32 v123, 0xffff0000, v205
    v_lshlrev_b32 v75, 16, v206
    v_and_b32 v139, 0xffff0000, v206
    v_lshlrev_b32 v91, 16, v207
    v_and_b32 v155, 0xffff0000, v207
    s_waitcnt vmcnt(13)
    v_lshlrev_b32 v44, 16, v208
    v_and_b32 v108, 0xffff0000, v208
    buffer_load_dwordx4 v19, s[24:27], s38 offen offset:2048 sc1 lds
    v_lshlrev_b32 v60, 16, v209
    v_and_b32 v124, 0xffff0000, v209
    v_lshlrev_b32 v76, 16, v210
    v_and_b32 v140, 0xffff0000, v210
    v_lshlrev_b32 v92, 16, v211
    v_and_b32 v156, 0xffff0000, v211
    s_waitcnt vmcnt(13)
    v_lshlrev_b32 v45, 16, v212
    v_and_b32 v109, 0xffff0000, v212
    v_lshlrev_b32 v61, 16, v213
    v_and_b32 v125, 0xffff0000, v213
    v_lshlrev_b32 v77, 16, v214
    v_and_b32 v141, 0xffff0000, v214
    v_lshlrev_b32 v93, 16, v215
    v_and_b32 v157, 0xffff0000, v215
    buffer_load_dwordx4 v19, s[24:27], s38 offen offset:3072 sc1 lds
    s_waitcnt vmcnt(13)
    v_lshlrev_b32 v46, 16, v216
    v_and_b32 v110, 0xffff0000, v216
    v_lshlrev_b32 v62, 16, v217
    v_and_b32 v126, 0xffff0000, v217
    v_lshlrev_b32 v78, 16, v218
    v_and_b32 v142, 0xffff0000, v218
    v_lshlrev_b32 v94, 16, v219
    v_and_b32 v158, 0xffff0000, v219
    s_waitcnt vmcnt(12)
    v_lshlrev_b32 v47, 16, v220
    v_and_b32 v111, 0xffff0000, v220
    v_lshlrev_b32 v63, 16, v221
    v_and_b32 v127, 0xffff0000, v221
    v_lshlrev_b32 v79, 16, v222
    v_and_b32 v143, 0xffff0000, v222
    v_lshlrev_b32 v95, 16, v223
    v_and_b32 v159, 0xffff0000, v223
    s_cmp_lg_u32 s37, 111
    s_cbranch_scc1 L_nonyq
    v_pk_mul_f32 v[96:97], v[96:97], 0.5 op_sel_hi:[1,0]
    v_pk_mul_f32 v[98:99], v[98:99], 0.5 op_sel_hi:[1,0]
    v_pk_mul_f32 v[100:101], v[100:101], 0.5 op_sel_hi:[1,0]
    v_pk_mul_f32 v[102:103], v[102:103], 0.5 op_sel_hi:[1,0]
    v_pk_mul_f32 v[104:105], v[104:105], 0.5 op_sel_hi:[1,0]
    v_pk_mul_f32 v[106:107], v[106:107], 0.5 op_sel_hi:[1,0]
    v_pk_mul_f32 v[108:109], v[108:109], 0.5 op_sel_hi:[1,0]
    v_pk_mul_f32 v[110:111], v[110:111], 0.5 op_sel_hi:[1,0]
    v_pk_mul_f32 v[112:113], v[112:113], 0.5 op_sel_hi:[1,0]
    v_pk_mul_f32 v[114:115], v[114:115], 0.5 op_sel_hi:[1,0]
    v_pk_mul_f32 v[116:117], v[116:117], 0.5 op_sel_hi:[1,0]
    v_pk_mul_f32 v[118:119], v[118:119], 0.5 op_sel_hi:[1,0]
    v_pk_mul_f32 v[120:121], v[120:121], 0.5 op_sel_hi:[1,0]
    v_pk_mul_f32 v[122:123], v[122:123], 0.5 op_sel_hi:[1,0]
    v_pk_mul_f32 v[124:125], v[124:125], 0.5 op_sel_hi:[1,0]
    v_pk_mul_f32 v[126:127], v[126:127], 0.5 op_sel_hi:[1,0]
    v_pk_mul_f32 v[128:129], v[128:129], 0.5 op_sel_hi:[1,0]
    v_pk_mul_f32 v[130:131], v[130:131], 0.5 op_sel_hi:[1,0]
    v_pk_mul_f32 v[132:133], v[132:133], 0.5 op_sel_hi:[1,0]
    v_pk_mul_f32 v[134:135], v[134:135], 0.5 op_sel_hi:[1,0]
    v_pk_mul_f32 v[136:137], v[136:137], 0.5 op_sel_hi:[1,0]
    v_pk_mul_f32 v[138:139], v[138:139], 0.5 op_sel_hi:[1,0]
    v_pk_mul_f32 v[140:141], v[140:141], 0.5 op_sel_hi:[1,0]
    v_pk_mul_f32 v[142:143], v[142:143], 0.5 op_sel_hi:[1,0]
    v_pk_mul_f32 v[144:145], v[144:145], 0.5 op_sel_hi:[1,0]
    v_pk_mul_f32 v[146:147], v[146:147], 0.5 op_sel_hi:[1,0]
    v_pk_mul_f32 v[148:149], v[148:149], 0.5 op_sel_hi:[1,0]
    v_pk_mul_f32 v[150:151], v[150:151], 0.5 op_sel_hi:[1,0]
    v_pk_mul_f32 v[152:153], v[152:153], 0.5 op_sel_hi:[1,0]
    v_pk_mul_f32 v[154:155], v[154:155], 0.5 op_sel_hi:[1,0]
    v_pk_mul_f32 v[156:157], v[156:157], 0.5 op_sel_hi:[1,0]
    v_pk_mul_f32 v[158:159], v[158:159], 0.5 op_sel_hi:[1,0]
L_nonyq:
    s_waitcnt vmcnt(4) lgkmcnt(0)
    s_barrier
    s_add_u32 m0, s41, 36864
    s_add_u32 s38, s40, 36864
    buffer_load_dwordx4 v19, s[24:27], s38 offen offset:0 sc1 lds
    buffer_load_dwordx4 v19, s[24:27], s38 offen offset:1024 sc1 lds
    buffer_load_dwordx4 v19, s[24:27], s38 offen offset:2048 sc1 lds
    buffer_load_dwordx4 v19, s[24:27], s38 offen offset:3072 sc1 lds
    ds_read_b64_tr_b16 a[80:81], v14 offset:0
    ds_read_b64_tr_b16 a[82:83], v14 offset:4096
    ds_read_b64_tr_b16 a[96:97], v15 offset:0
    ds_read_b64_tr_b16 a[98:99], v15 offset:4096
    ds_read_b64_tr_b16 a[84:85], v14 offset:8192
    ds_read_b64_tr_b16 a[86:87], v14 offset:12288
    ds_read_b64_tr_b16 a[100:101], v15 offset:8192
    ds_read_b64_tr_b16 a[102:103], v15 offset:12288
    s_waitcnt lgkmcnt(6)
    v_mfma_f32_32x32x16_bf16 v[160:175], a[0:3], a[80:83], 0
    ds_read_b64_tr_b16 a[88:89], v14 offset:16384
    ds_read_b64_tr_b16 a[90:91], v14 offset:20480
    v_mfma_f32_32x32x16_bf16 v[176:191], a[16:19], a[80:83], 0
    ds_read_b64_tr_b16 a[104:105], v15 offset:16384
    ds_read_b64_tr_b16 a[106:107], v15 offset:20480
    s_waitcnt lgkmcnt(8)
    v_mfma_f32_32x32x16_bf16 v[160:175], a[8:11], a[96:99], v[160:175]
    ds_read_b64_tr_b16 a[92:93], v14 offset:24576
    ds_read_b64_tr_b16 a[94:95], v14 offset:28672
    v_mfma_f32_32x32x16_bf16 v[176:191], a[0:3], a[96:99], v[176:191]
    ds_read_b64_tr_b16 a[108:109], v15 offset:24576
    ds_read_b64_tr_b16 a[110:111], v15 offset:28672
    s_waitcnt lgkmcnt(10)
    v_mfma_f32_32x32x16_bf16 v[160:175], a[4:7], a[84:87], v[160:175]
    v_mfma_f32_32x32x16_bf16 v[176:191], a[20:23], a[84:87], v[176:191]
    s_waitcnt lgkmcnt(8)
    v_mfma_f32_32x32x16_bf16 v[160:175], a[12:15], a[100:103], v[160:175]
    v_mfma_f32_32x32x16_bf16 v[176:191], a[4:7], a[100:103], v[176:191]
    s_waitcnt lgkmcnt(6)
    v_mfma_f32_32x32x16_bf16 v[160:175], a[0:3], a[88:91], v[160:175]
    v_mfma_f32_32x32x16_bf16 v[176:191], a[16:19], a[88:91], v[176:191]
    s_waitcnt lgkmcnt(4)
    v_mfma_f32_32x32x16_bf16 v[160:175], a[8:11], a[104:107], v[160:175]
    v_mfma_f32_32x32x16_bf16 v[176:191], a[0:3], a[104:107], v[176:191]
    s_waitcnt lgkmcnt(2)
    v_mfma_f32_32x32x16_bf16 v[160:175], a[4:7], a[92:95], v[160:175]
    v_mfma_f32_32x32x16_bf16 v[176:191], a[20:23], a[92:95], v[176:191]
    s_waitcnt lgkmcnt(0)
    v_mfma_f32_32x32x16_bf16 v[160:175], a[12:15], a[108:111], v[160:175]
    v_mfma_f32_32x32x16_bf16 v[176:191], a[4:7], a[108:111], v[176:191]
    v_mfma_f32_32x32x16_bf16 v[192:207], a[24:27], a[80:83], 0
    s_nop 4
    v_mfma_f32_32x32x16_bf16 v[208:223], a[48:51], a[80:83], 0
    s_nop 4
    v_mfma_f32_32x32x16_bf16 v[192:207], a[40:43], a[96:99], v[192:207]
    v_mul_f32 v4, v160, v32
    v_mul_f32 v5, v160, v48
    v_fma_f32 v4, -v176, v48, v4
    v_fmac_f32 v5, v176, v32
    v_mul_f32 v6, v161, v33
    v_mul_f32 v7, v161, v49
    v_mfma_f32_32x32x16_bf16 v[208:223], a[24:27], a[96:99], v[208:223]
    v_fma_f32 v6, -v177, v49, v6
    v_fmac_f32 v7, v177, v33
    v_cvt_pk_bf16_f32 v32, v4, v6
    v_cvt_pk_bf16_f32 v48, v5, v7
    v_mul_f32 v8, v162, v34
    v_mul_f32 v9, v162, v50
    v_mfma_f32_32x32x16_bf16 v[192:207], a[28:31], a[84:87], v[192:207]
    v_fma_f32 v8, -v178, v50, v8
    v_fmac_f32 v9, v178, v34
    v_mul_f32 v10, v163, v35
    v_mul_f32 v11, v163, v51
    v_fma_f32 v10, -v179, v51, v10
    v_fmac_f32 v11, v179, v35
    v_mfma_f32_32x32x16_bf16 v[208:223], a[52:55], a[84:87], v[208:223]
    v_cvt_pk_bf16_f32 v33, v8, v10
    v_cvt_pk_bf16_f32 v49, v9, v11
    v_mul_f32 v4, v164, v36
    v_mul_f32 v5, v164, v52
    v_fma_f32 v4, -v180, v52, v4
    v_fmac_f32 v5, v180, v36
    v_mfma_f32_32x32x16_bf16 v[192:207], a[44:47], a[100:103], v[192:207]
    v_mul_f32 v6, v165, v37
    v_mul_f32 v7, v165, v53
    v_fma_f32 v6, -v181, v53, v6
    v_fmac_f32 v7, v181, v37
    v_cvt_pk_bf16_f32 v34, v4, v6
    v_cvt_pk_bf16_f32 v50, v5, v7
    v_mfma_f32_32x32x16_bf16 v[208:223], a[28:31], a[100:103], v[208:223]
    v_mul_f32 v8, v166, v38
    v_mul_f32 v9, v166, v54
    v_fma_f32 v8, -v182, v54, v8
    v_fmac_f32 v9, v182, v38
    v_mul_f32 v10, v167, v39
    v_mul_f32 v11, v167, v55
    v_mfma_f32_32x32x16_bf16 v[192:207], a[32:35], a[88:91], v[192:207]
    v_fma_f32 v10, -v183, v55, v10
    v_fmac_f32 v11, v183, v39
    v_cvt_pk_bf16_f32 v35, v8, v10
    v_cvt_pk_bf16_f32 v51, v9, v11
    v_mul_f32 v4, v168, v40
    v_mul_f32 v5, v168, v56
    v_mfma_f32_32x32x16_bf16 v[208:223], a[40:43], a[88:91], v[208:223]
    v_fma_f32 v4, -v184, v56, v4
    v_fmac_f32 v5, v184, v40
    v_mul_f32 v6, v169, v41
    v_mul_f32 v7, v169, v57
    v_fma_f32 v6, -v185, v57, v6
    v_fmac_f32 v7, v185, v41
    v_mfma_f32_32x32x16_bf16 v[192:207], a[48:51], a[104:107], v[192:207]
    v_cvt_pk_bf16_f32 v36, v4, v6
    v_cvt_pk_bf16_f32 v52, v5, v7
    v_mul_f32 v8, v170, v42
    v_mul_f32 v9, v170, v58
    v_fma_f32 v8, -v186, v58, v8
    v_fmac_f32 v9, v186, v42
    v_mfma_f32_32x32x16_bf16 v[208:223], a[32:35], a[104:107], v[208:223]
    s_waitcnt vmcnt(0)
    s_barrier
    ds_read_b64_tr_b16 a[112:113], v14 offset:32768
    ds_read_b64_tr_b16 a[114:115], v14 offset:36864
    v_mul_f32 v10, v171, v43
    v_mul_f32 v11, v171, v59
    v_mfma_f32_32x32x16_bf16 v[192:207], a[36:39], a[92:95], v[192:207]
    ds_read_b64_tr_b16 a[128:129], v15 offset:32768
    ds_read_b64_tr_b16 a[130:131], v15 offset:36864
    v_fma_f32 v10, -v187, v59, v10
    v_fmac_f32 v11, v187, v43
    v_cvt_pk_bf16_f32 v37, v8, v10
    v_mfma_f32_32x32x16_bf16 v[208:223], a[44:47], a[92:95], v[208:223]
    ds_read_b64_tr_b16 a[116:117], v14 offset:40960
    ds_read_b64_tr_b16 a[118:119], v14 offset:45056
    v_cvt_pk_bf16_f32 v53, v9, v11
    v_mul_f32 v4, v172, v44
    v_mul_f32 v5, v172, v60
    v_mfma_f32_32x32x16_bf16 v[192:207], a[52:55], a[108:111], v[192:207]
    ds_read_b64_tr_b16 a[132:133], v15 offset:40960
    ds_read_b64_tr_b16 a[134:135], v15 offset:45056
    v_fma_f32 v4, -v188, v60, v4
    v_fmac_f32 v5, v188, v44
    v_mul_f32 v6, v173, v45
    v_mfma_f32_32x32x16_bf16 v[208:223], a[36:39], a[108:111], v[208:223]
    v_mul_f32 v7, v173, v61
    v_fma_f32 v6, -v189, v61, v6
    v_fmac_f32 v7, v189, v45
    v_cvt_pk_bf16_f32 v38, v4, v6
    v_cvt_pk_bf16_f32 v54, v5, v7
    v_mul_f32 v8, v174, v46
    v_mul_f32 v9, v174, v62
    v_fma_f32 v8, -v190, v62, v8
    v_fmac_f32 v9, v190, v46
    v_mul_f32 v10, v175, v47
    v_mul_f32 v11, v175, v63
    v_fma_f32 v10, -v191, v63, v10
    v_fmac_f32 v11, v191, v47
    v_cvt_pk_bf16_f32 v39, v8, v10
    v_cvt_pk_bf16_f32 v55, v9, v11
    s_waitcnt lgkmcnt(6)
    v_mfma_f32_32x32x16_bf16 v[160:175], a[0:3], a[112:115], 0
    ds_read_b64_tr_b16 a[120:121], v14 offset:49152
    ds_read_b64_tr_b16 a[122:123], v14 offset:53248
    ds_read_b64_tr_b16 a[136:137], v15 offset:49152
    ds_read_b64_tr_b16 a[138:139], v15 offset:53248
    v_mfma_f32_32x32x16_bf16 v[176:191], a[16:19], a[112:115], 0
    ds_read_b64_tr_b16 a[124:125], v14 offset:57344
    ds_read_b64_tr_b16 a[126:127], v14 offset:61440
    ds_read_b64_tr_b16 a[140:141], v15 offset:57344
    ds_read_b64_tr_b16 a[142:143], v15 offset:61440
    s_waitcnt lgkmcnt(12)
    v_mfma_f32_32x32x16_bf16 v[160:175], a[8:11], a[128:131], v[160:175]
    v_mul_f32 v4, v192, v64
    v_mul_f32 v5, v192, v80
    v_fma_f32 v4, -v208, v80, v4
    v_fmac_f32 v5, v208, v64
    v_mul_f32 v6, v193, v65
    v_mul_f32 v7, v193, v81
    v_mfma_f32_32x32x16_bf16 v[176:191], a[0:3], a[128:131], v[176:191]
    v_fma_f32 v6, -v209, v81, v6
    v_fmac_f32 v7, v209, v65
    v_cvt_pk_bf16_f32 v64, v4, v6
    v_cvt_pk_bf16_f32 v80, v5, v7
    v_mul_f32 v8, v194, v66
    v_mul_f32 v9, v194, v82
    s_waitcnt lgkmcnt(10)
    v_mfma_f32_32x32x16_bf16 v[160:175], a[4:7], a[116:119], v[160:175]
    v_fma_f32 v8, -v210, v82, v8
    v_fmac_f32 v9, v210, v66
    v_mul_f32 v10, v195, v67
    v_mul_f32 v11, v195, v83
    v_fma_f32 v10, -v211, v83, v10
    v_fmac_f32 v11, v211, v67
    v_mfma_f32_32x32x16_bf16 v[176:191], a[20:23], a[116:119], v[176:191]
    v_cvt_pk_bf16_f32 v65, v8, v10
    v_cvt_pk_bf16_f32 v81, v9, v11
    v_mul_f32 v4, v196, v68
    v_mul_f32 v5, v196, v84
    v_fma_f32 v4, -v212, v84, v4
    v_fmac_f32 v5, v212, v68
    s_waitcnt lgkmcnt(8)
    v_mfma_f32_32x32x16_bf16 v[160:175], a[12:15], a[132:135], v[160:175]
    v_mul_f32 v6, v197, v69
    v_mul_f32 v7, v197, v85
    v_fma_f32 v6, -v213, v85, v6
    v_fmac_f32 v7, v213, v69
    v_cvt_pk_bf16_f32 v66, v4, v6
    v_cvt_pk_bf16_f32 v82, v5, v7
    v_mfma_f32_32x32x16_bf16 v[176:191], a[4:7], a[132:135], v[176:191]
    v_mul_f32 v8, v198, v70
    v_mul_f32 v9, v198, v86
    v_fma_f32 v8, -v214, v86, v8
    v_fmac_f32 v9, v214, v70
    v_mul_f32 v10, v199, v71
    v_mul_f32 v11, v199, v87
    s_waitcnt lgkmcnt(6)
    v_mfma_f32_32x32x16_bf16 v[160:175], a[0:3], a[120:123], v[160:175]
    v_fma_f32 v10, -v215, v87, v10
    v_fmac_f32 v11, v215, v71
    v_cvt_pk_bf16_f32 v67, v8, v10
    v_cvt_pk_bf16_f32 v83, v9, v11
    v_mul_f32 v4, v200, v72
    v_mul_f32 v5, v200, v88
    v_mfma_f32_32x32x16_bf16 v[176:191], a[16:19], a[120:123], v[176:191]
    v_fma_f32 v4, -v216, v88, v4
    v_fmac_f32 v5, v216, v72
    v_mul_f32 v6, v201, v73
    v_mul_f32 v7, v201, v89
    v_fma_f32 v6, -v217, v89, v6
    v_fmac_f32 v7, v217, v73
    s_waitcnt lgkmcnt(4)
    v_mfma_f32_32x32x16_bf16 v[160:175], a[8:11], a[136:139], v[160:175]
    v_cvt_pk_bf16_f32 v68, v4, v6
    v_cvt_pk_bf16_f32 v84, v5, v7
    v_mul_f32 v8, v202, v74
    v_mul_f32 v9, v202, v90
    v_fma_f32 v8, -v218, v90, v8
    v_fmac_f32 v9, v218, v74
    v_mfma_f32_32x32x16_bf16 v[176:191], a[0:3], a[136:139], v[176:191]
    v_mul_f32 v10, v203, v75
    v_mul_f32 v11, v203, v91
    v_fma_f32 v10, -v219, v91, v10
    v_fmac_f32 v11, v219, v75
    v_cvt_pk_bf16_f32 v69, v8, v10
    v_cvt_pk_bf16_f32 v85, v9, v11
    s_waitcnt lgkmcnt(2)
    v_mfma_f32_32x32x16_bf16 v[160:175], a[4:7], a[124:127], v[160:175]
    v_mul_f32 v4, v204, v76
    v_mul_f32 v5, v204, v92
    v_fma_f32 v4, -v220, v92, v4
    v_fmac_f32 v5, v220, v76
    v_mul_f32 v6, v205, v77
    v_mul_f32 v7, v205, v93
    v_mfma_f32_32x32x16_bf16 v[176:191], a[20:23], a[124:127], v[176:191]
    v_fma_f32 v6, -v221, v93, v6
    v_fmac_f32 v7, v221, v77
    v_cvt_pk_bf16_f32 v70, v4, v6
    v_cvt_pk_bf16_f32 v86, v5, v7
    v_mul_f32 v8, v206, v78
    v_mul_f32 v9, v206, v94
    s_waitcnt lgkmcnt(0)
    v_mfma_f32_32x32x16_bf16 v[160:175], a[12:15], a[140:143], v[160:175]
    v_fma_f32 v8, -v222, v94, v8
    v_fmac_f32 v9, v222, v78
    v_mul_f32 v10, v207, v79
    v_mul_f32 v11, v207, v95
    v_fma_f32 v10, -v223, v95, v10
    v_fmac_f32 v11, v223, v79
    v_mfma_f32_32x32x16_bf16 v[176:191], a[4:7], a[140:143], v[176:191]
    v_cvt_pk_bf16_f32 v71, v8, v10
    v_cvt_pk_bf16_f32 v87, v9, v11
    v_mfma_f32_32x32x16_bf16 v[192:207], a[24:27], a[112:115], 0
    s_nop 4
    v_mfma_f32_32x32x16_bf16 v[208:223], a[48:51], a[112:115], 0
    s_nop 4
    v_mfma_f32_32x32x16_bf16 v[192:207], a[40:43], a[128:131], v[192:207]
    v_mul_f32 v4, v160, v96
    v_mul_f32 v5, v160, v112
    v_fma_f32 v4, -v176, v112, v4
    v_fmac_f32 v5, v176, v96
    v_mul_f32 v6, v161, v97
    v_mul_f32 v7, v161, v113
    v_mfma_f32_32x32x16_bf16 v[208:223], a[24:27], a[128:131], v[208:223]
    v_fma_f32 v6, -v177, v113, v6
    v_fmac_f32 v7, v177, v97
    v_cvt_pk_bf16_f32 v96, v4, v6
    v_cvt_pk_bf16_f32 v112, v5, v7
    v_mul_f32 v8, v162, v98
    v_mul_f32 v9, v162, v114
    v_mfma_f32_32x32x16_bf16 v[192:207], a[28:31], a[116:119], v[192:207]
    v_fma_f32 v8, -v178, v114, v8
    v_fmac_f32 v9, v178, v98
    v_mul_f32 v10, v163, v99
    v_mul_f32 v11, v163, v115
    v_fma_f32 v10, -v179, v115, v10
    v_fmac_f32 v11, v179, v99
    v_mfma_f32_32x32x16_bf16 v[208:223], a[52:55], a[116:119], v[208:223]
    v_cvt_pk_bf16_f32 v97, v8, v10
    v_cvt_pk_bf16_f32 v113, v9, v11
    v_mul_f32 v4, v164, v100
    v_mul_f32 v5, v164, v116
    v_fma_f32 v4, -v180, v116, v4
    v_fmac_f32 v5, v180, v100
    v_mfma_f32_32x32x16_bf16 v[192:207], a[44:47], a[132:135], v[192:207]
    v_mul_f32 v6, v165, v101
    v_mul_f32 v7, v165, v117
    v_fma_f32 v6, -v181, v117, v6
    v_fmac_f32 v7, v181, v101
    v_cvt_pk_bf16_f32 v98, v4, v6
    v_cvt_pk_bf16_f32 v114, v5, v7
    v_mfma_f32_32x32x16_bf16 v[208:223], a[28:31], a[132:135], v[208:223]
    v_mul_f32 v8, v166, v102
    v_mul_f32 v9, v166, v118
    v_fma_f32 v8, -v182, v118, v8
    v_fmac_f32 v9, v182, v102
    v_mul_f32 v10, v167, v103
    v_mul_f32 v11, v167, v119
    v_mfma_f32_32x32x16_bf16 v[192:207], a[32:35], a[120:123], v[192:207]
    v_fma_f32 v10, -v183, v119, v10
    v_fmac_f32 v11, v183, v103
    v_cvt_pk_bf16_f32 v99, v8, v10
    v_cvt_pk_bf16_f32 v115, v9, v11
    v_mul_f32 v4, v168, v104
    v_mul_f32 v5, v168, v120
    v_mfma_f32_32x32x16_bf16 v[208:223], a[40:43], a[120:123], v[208:223]
    v_fma_f32 v4, -v184, v120, v4
    v_fmac_f32 v5, v184, v104
    v_mul_f32 v6, v169, v105
    v_mul_f32 v7, v169, v121
    v_fma_f32 v6, -v185, v121, v6
    v_fmac_f32 v7, v185, v105
    v_mfma_f32_32x32x16_bf16 v[192:207], a[48:51], a[136:139], v[192:207]
    v_cvt_pk_bf16_f32 v100, v4, v6
    v_cvt_pk_bf16_f32 v116, v5, v7
    v_mul_f32 v8, v170, v106
    v_mul_f32 v9, v170, v122
    v_fma_f32 v8, -v186, v122, v8
    v_fmac_f32 v9, v186, v106
    v_mfma_f32_32x32x16_bf16 v[208:223], a[32:35], a[136:139], v[208:223]
    v_mul_f32 v10, v171, v107
    v_mul_f32 v11, v171, v123
    v_fma_f32 v10, -v187, v123, v10
    v_fmac_f32 v11, v187, v107
    v_cvt_pk_bf16_f32 v101, v8, v10
    v_cvt_pk_bf16_f32 v117, v9, v11
    v_mfma_f32_32x32x16_bf16 v[192:207], a[36:39], a[124:127], v[192:207]
    v_mul_f32 v4, v172, v108
    v_mul_f32 v5, v172, v124
    v_fma_f32 v4, -v188, v124, v4
    v_fmac_f32 v5, v188, v108
    v_mul_f32 v6, v173, v109
    v_mul_f32 v7, v173, v125
    v_mfma_f32_32x32x16_bf16 v[208:223], a[44:47], a[124:127], v[208:223]
    v_fma_f32 v6, -v189, v125, v6
    v_fmac_f32 v7, v189, v109
    v_cvt_pk_bf16_f32 v102, v4, v6
    v_cvt_pk_bf16_f32 v118, v5, v7
    v_mul_f32 v8, v174, v110
    v_mul_f32 v9, v174, v126
    v_mfma_f32_32x32x16_bf16 v[192:207], a[52:55], a[140:143], v[192:207]
    v_fma_f32 v8, -v190, v126, v8
    v_fmac_f32 v9, v190, v110
    v_mul_f32 v10, v175, v111
    v_mul_f32 v11, v175, v127
    v_fma_f32 v10, -v191, v127, v10
    v_fmac_f32 v11, v191, v111
    v_mfma_f32_32x32x16_bf16 v[208:223], a[36:39], a[140:143], v[208:223]
    v_cvt_pk_bf16_f32 v103, v8, v10
    v_cvt_pk_bf16_f32 v119, v9, v11
    v_mfma_f32_32x32x16_bf16 v[224:239], v[32:35], a[0:3], 0
L_stubA2:
    s_cbranch_execz L_retA
    s_nop 4
    v_mfma_f32_32x32x16_bf16 v[240:255], v[32:35], a[8:11], 0
    s_nop 4
    v_mfma_f32_32x32x16_bf16 v[224:239], v[48:51], a[16:19], v[224:239]
    v_mul_f32 v4, v192, v128
    v_mul_f32 v5, v192, v144
    v_fma_f32 v4, -v208, v144, v4
    v_fmac_f32 v5, v208, v128
    v_mul_f32 v6, v193, v129
    v_mul_f32 v7, v193, v145
    v_mfma_f32_32x32x16_bf16 v[240:255], v[48:51], a[0:3], v[240:255]
    v_fma_f32 v6, -v209, v145, v6
    v_fmac_f32 v7, v209, v129
    v_cvt_pk_bf16_f32 v128, v4, v6
    v_cvt_pk_bf16_f32 v144, v5, v7
    v_mul_f32 v8, v194, v130
    v_mul_f32 v9, v194, v146
    v_mfma_f32_32x32x16_bf16 v[224:239], v[36:39], a[4:7], v[224:239]
    v_fma_f32 v8, -v210, v146, v8
    v_fmac_f32 v9, v210, v130
    v_mul_f32 v10, v195, v131
    v_mul_f32 v11, v195, v147
    v_fma_f32 v10, -v211, v147, v10
    v_fmac_f32 v11, v211, v131
    v_mfma_f32_32x32x16_bf16 v[240:255], v[36:39], a[12:15], v[240:255]
    v_cvt_pk_bf16_f32 v129, v8, v10
    v_cvt_pk_bf16_f32 v145, v9, v11
    v_mul_f32 v4, v196, v132
    v_mul_f32 v5, v196, v148
    v_fma_f32 v4, -v212, v148, v4
    v_fmac_f32 v5, v212, v132
    v_mfma_f32_32x32x16_bf16 v[224:239], v[52:55], a[20:23], v[224:239]
    v_mul_f32 v6, v197, v133
    v_mul_f32 v7, v197, v149
    v_fma_f32 v6, -v213, v149, v6
    v_fmac_f32 v7, v213, v133
    v_cvt_pk_bf16_f32 v130, v4, v6
    v_cvt_pk_bf16_f32 v146, v5, v7
    v_mfma_f32_32x32x16_bf16 v[240:255], v[52:55], a[4:7], v[240:255]
    v_mul_f32 v8, v198, v134
    v_mul_f32 v9, v198, v150
    v_fma_f32 v8, -v214, v150, v8
    v_fmac_f32 v9, v214, v134
    v_mul_f32 v10, v199, v135
    v_mul_f32 v11, v199, v151
    v_mfma_f32_32x32x16_bf16 v[160:175], v[64:67], a[56:59], 0
    v_fma_f32 v10, -v215, v151, v10
    v_fmac_f32 v11, v215, v135
    v_cvt_pk_bf16_f32 v131, v8, v10
    v_cvt_pk_bf16_f32 v147, v9, v11
    v_mul_f32 v4, v200, v136
    v_mul_f32 v5, v200, v152
    v_mfma_f32_32x32x16_bf16 v[176:191], v[64:67], a[64:67], 0
    v_fma_f32 v4, -v216, v152, v4
    v_fmac_f32 v5, v216, v136
    v_mul_f32 v6, v201, v137
    v_mul_f32 v7, v201, v153
    v_fma_f32 v6, -v217, v153, v6
    v_fmac_f32 v7, v217, v137
    v_mfma_f32_32x32x16_bf16 v[160:175], v[80:83], a[72:75], v[160:175]
    v_cvt_pk_bf16_f32 v132, v4, v6
    v_cvt_pk_bf16_f32 v148, v5, v7
    v_mul_f32 v8, v202, v138
    v_mul_f32 v9, v202, v154
    v_fma_f32 v8, -v218, v154, v8
    v_fmac_f32 v9, v218, v138
    v_mfma_f32_32x32x16_bf16 v[176:191], v[80:83], a[56:59], v[176:191]
    v_mul_f32 v10, v203, v139
    v_mul_f32 v11, v203, v155
    v_fma_f32 v10, -v219, v155, v10
    v_fmac_f32 v11, v219, v139
    v_cvt_pk_bf16_f32 v133, v8, v10
    v_cvt_pk_bf16_f32 v149, v9, v11
    v_mfma_f32_32x32x16_bf16 v[160:175], v[68:71], a[60:63], v[160:175]
    v_mul_f32 v4, v204, v140
    v_mul_f32 v5, v204, v156
    v_fma_f32 v4, -v220, v156, v4
    v_fmac_f32 v5, v220, v140
    v_mul_f32 v6, v205, v141
    v_mul_f32 v7, v205, v157
    v_mfma_f32_32x32x16_bf16 v[176:191], v[68:71], a[68:71], v[176:191]
    v_fma_f32 v6, -v221, v157, v6
    v_fmac_f32 v7, v221, v141
    v_cvt_pk_bf16_f32 v134, v4, v6
    v_cvt_pk_bf16_f32 v150, v5, v7
    v_mul_f32 v8, v206, v142
    v_mul_f32 v9, v206, v158
    v_mfma_f32_32x32x16_bf16 v[160:175], v[84:87], a[76:79], v[160:175]
    v_fma_f32 v8, -v222, v158, v8
    v_fmac_f32 v9, v222, v142
    v_mul_f32 v10, v207, v143
    v_mul_f32 v11, v207, v159
    v_fma_f32 v10, -v223, v159, v10
    v_fmac_f32 v11, v223, v143
    v_mfma_f32_32x32x16_bf16 v[176:191], v[84:87], a[60:63], v[176:191]
    v_cvt_pk_bf16_f32 v135, v8, v10
    v_cvt_pk_bf16_f32 v151, v9, v11
    v_mfma_f32_32x32x16_bf16 v[64:79], v[96:99], a[0:3], 0
    s_nop 2
    ds_read_b128 v[24:27], v22 offset:0
    ds_read_b128 v[28:31], v22 offset:1024
    v_mfma_f32_32x32x16_bf16 v[80:95], v[96:99], a[8:11], 0
    s_nop 2
    ds_read_b128 v[104:107], v22 offset:2048
    ds_read_b128 v[108:111], v22 offset:3072
    v_mfma_f32_32x32x16_bf16 v[64:79], v[112:115], a[16:19], v[64:79]
    v_add_f32 v4, v224, v160
    v_add_f32 v5, v240, v176
    v_sub_f32 v160, v224, v160
    v_sub_f32 v176, v240, v176
    s_waitcnt lgkmcnt(3)
    v_mul_f32 v6, v4, v24
    s_waitcnt lgkmcnt(2)
    v_mul_f32 v7, v4, v28
    v_mfma_f32_32x32x16_bf16 v[80:95], v[112:115], a[0:3], v[80:95]
    v_fma_f32 v6, -v5, v28, v6
    v_fmac_f32 v7, v5, v24
    v_add_f32 v8, v225, v161
    v_add_f32 v9, v241, v177
    v_sub_f32 v161, v225, v161
    v_sub_f32 v177, v241, v177
    v_mfma_f32_32x32x16_bf16 v[64:79], v[100:103], a[4:7], v[64:79]
    v_mul_f32 v10, v8, v25
    v_mul_f32 v11, v8, v29
    v_fma_f32 v10, -v9, v29, v10
    v_fmac_f32 v11, v9, v25
    v_cvt_pk_bf16_f32 v32, v6, v10
    v_cvt_pk_bf16_f32 v40, v7, v11
    v_mfma_f32_32x32x16_bf16 v[80:95], v[100:103], a[12:15], v[80:95]
    v_add_f32 v4, v226, v162
    v_add_f32 v5, v242, v178
    v_sub_f32 v162, v226, v162
    v_sub_f32 v178, v242, v178
    v_mul_f32 v6, v4, v26
    v_mul_f32 v7, v4, v30
    v_mfma_f32_32x32x16_bf16 v[64:79], v[116:119], a[20:23], v[64:79]
    v_fma_f32 v6, -v5, v30, v6
    v_fmac_f32 v7, v5, v26
    v_add_f32 v8, v227, v163
    v_add_f32 v9, v243, v179
    v_sub_f32 v163, v227, v163
    v_sub_f32 v179, v243, v179
    v_mfma_f32_32x32x16_bf16 v[80:95], v[116:119], a[4:7], v[80:95]
    v_mul_f32 v10, v8, v27
    v_mul_f32 v11, v8, v31
    v_fma_f32 v10, -v9, v31, v10
    v_fmac_f32 v11, v9, v27
    v_cvt_pk_bf16_f32 v33, v6, v10
    v_cvt_pk_bf16_f32 v41, v7, v11
    v_mfma_f32_32x32x16_bf16 v[192:207], v[128:131], a[56:59], 0
    ds_read_b128 v[24:27], v22 offset:4096
    ds_read_b128 v[28:31], v22 offset:5120
    v_add_f32 v4, v228, v164
    v_add_f32 v5, v244, v180
    v_sub_f32 v164, v228, v164
    v_mfma_f32_32x32x16_bf16 v[208:223], v[128:131], a[64:67], 0
    v_sub_f32 v180, v244, v180
    s_waitcnt lgkmcnt(3)
    v_mul_f32 v6, v4, v104
    s_waitcnt lgkmcnt(2)
    v_mul_f32 v7, v4, v108
    v_fma_f32 v6, -v5, v108, v6
    v_fmac_f32 v7, v5, v104
    v_add_f32 v8, v229, v165
    v_mfma_f32_32x32x16_bf16 v[192:207], v[144:147], a[72:75], v[192:207]
    v_add_f32 v9, v245, v181
    v_sub_f32 v165, v229, v165
    v_sub_f32 v181, v245, v181
    v_mul_f32 v10, v8, v105
    v_mul_f32 v11, v8, v109
    v_fma_f32 v10, -v9, v109, v10
    v_mfma_f32_32x32x16_bf16 v[208:223], v[144:147], a[56:59], v[208:223]
    v_fmac_f32 v11, v9, v105
    v_cvt_pk_bf16_f32 v34, v6, v10
    v_cvt_pk_bf16_f32 v42, v7, v11
    v_add_f32 v4, v230, v166
    v_add_f32 v5, v246, v182
    v_sub_f32 v166, v230, v166
    v_mfma_f32_32x32x16_bf16 v[192:207], v[132:135], a[60:63], v[192:207]
    v_sub_f32 v182, v246, v182
    v_mul_f32 v6, v4, v106
    v_mul_f32 v7, v4, v110
    v_fma_f32 v6, -v5, v110, v6
    v_fmac_f32 v7, v5, v106
    v_add_f32 v8, v231, v167
    v_mfma_f32_32x32x16_bf16 v[208:223], v[132:135], a[68:71], v[208:223]
    v_add_f32 v9, v247, v183
    v_sub_f32 v167, v231, v167
    v_sub_f32 v183, v247, v183
    v_mul_f32 v10, v8, v107
    v_mul_f32 v11, v8, v111
    v_fma_f32 v10, -v9, v111, v10
    v_mfma_f32_32x32x16_bf16 v[192:207], v[148:151], a[76:79], v[192:207]
    v_fmac_f32 v11, v9, v107
    v_cvt_pk_bf16_f32 v35, v6, v10
    v_cvt_pk_bf16_f32 v43, v7, v11
    v_mfma_f32_32x32x16_bf16 v[208:223], v[148:151], a[60:63], v[208:223]
    ds_read_b128 v[104:107], v22 offset:6144
    ds_read_b128 v[108:111], v22 offset:7168
    v_pk_add_f32 v[4:5], v[232:233], v[168:169]
    v_pk_add_f32 v[6:7], v[248:249], v[184:185]
    v_pk_add_f32 v[168:169], v[232:233], v[168:169] neg_lo:[0,1] neg_hi:[0,1]
    v_pk_add_f32 v[184:185], v[248:249], v[184:185] neg_lo:[0,1] neg_hi:[0,1]
    s_waitcnt lgkmcnt(3)
    v_pk_mul_f32 v[8:9], v[4:5], v[24:25]
    s_waitcnt lgkmcnt(2)
    v_pk_mul_f32 v[10:11], v[4:5], v[28:29]
    v_pk_fma_f32 v[8:9], v[6:7], v[28:29], v[8:9] neg_lo:[1,0,0] neg_hi:[1,0,0]
    v_pk_fma_f32 v[10:11], v[6:7], v[24:25], v[10:11]
    v_cvt_pk_bf16_f32 v36, v8, v9
    v_cvt_pk_bf16_f32 v44, v10, v11
    v_pk_add_f32 v[4:5], v[234:235], v[170:171]
    v_pk_add_f32 v[6:7], v[250:251], v[186:187]
    v_pk_add_f32 v[170:171], v[234:235], v[170:171] neg_lo:[0,1] neg_hi:[0,1]
    v_pk_add_f32 v[186:187], v[250:251], v[186:187] neg_lo:[0,1] neg_hi:[0,1]
    v_pk_mul_f32 v[8:9], v[4:5], v[26:27]
    v_pk_mul_f32 v[10:11], v[4:5], v[30:31]
    v_pk_fma_f32 v[8:9], v[6:7], v[30:31], v[8:9] neg_lo:[1,0,0] neg_hi:[1,0,0]
    v_pk_fma_f32 v[10:11], v[6:7], v[26:27], v[10:11]
    v_cvt_pk_bf16_f32 v37, v8, v9
    v_cvt_pk_bf16_f32 v45, v10, v11
    ds_read_b128 v[24:27], v22 offset:0
    ds_read_b128 v[28:31], v22 offset:1024
    v_pk_add_f32 v[4:5], v[236:237], v[172:173]
    v_pk_add_f32 v[6:7], v[252:253], v[188:189]
    v_pk_add_f32 v[172:173], v[236:237], v[172:173] neg_lo:[0,1] neg_hi:[0,1]
    v_pk_add_f32 v[188:189], v[252:253], v[188:189] neg_lo:[0,1] neg_hi:[0,1]
    s_waitcnt lgkmcnt(3)
    v_pk_mul_f32 v[8:9], v[4:5], v[104:105]
    s_waitcnt lgkmcnt(2)
    v_pk_mul_f32 v[10:11], v[4:5], v[108:109]
    v_pk_fma_f32 v[8:9], v[6:7], v[108:109], v[8:9] neg_lo:[1,0,0] neg_hi:[1,0,0]
    v_pk_fma_f32 v[10:11], v[6:7], v[104:105], v[10:11]
    v_cvt_pk_bf16_f32 v38, v8, v9
    v_cvt_pk_bf16_f32 v46, v10, v11
    v_pk_add_f32 v[4:5], v[238:239], v[174:175]
    v_pk_add_f32 v[6:7], v[254:255], v[190:191]
    v_pk_add_f32 v[174:175], v[238:239], v[174:175] neg_lo:[0,1] neg_hi:[0,1]
    v_pk_add_f32 v[190:191], v[254:255], v[190:191] neg_lo:[0,1] neg_hi:[0,1]
    v_pk_mul_f32 v[8:9], v[4:5], v[106:107]
    v_pk_mul_f32 v[10:11], v[4:5], v[110:111]
    v_pk_fma_f32 v[8:9], v[6:7], v[110:111], v[8:9] neg_lo:[1,0,0] neg_hi:[1,0,0]
    v_pk_fma_f32 v[10:11], v[6:7], v[106:107], v[10:11]
    v_cvt_pk_bf16_f32 v39, v8, v9
    v_cvt_pk_bf16_f32 v47, v10, v11
    ds_read_b128 v[104:107], v22 offset:2048
    ds_read_b128 v[108:111], v22 offset:3072
    v_mfma_f32_32x32x16_bf16 v[224:239], v[32:35], a[0:3], 0
    v_add_f32 v4, v64, v192
    v_add_f32 v5, v80, v208
    v_sub_f32 v192, v64, v192
    v_sub_f32 v208, v80, v208
    s_waitcnt lgkmcnt(3)
    v_mul_f32 v6, v4, v24
    s_waitcnt lgkmcnt(2)
    v_mul_f32 v7, v4, v28
    v_mfma_f32_32x32x16_bf16 v[240:255], v[32:35], a[8:11], 0
    v_fma_f32 v6, -v5, v28, v6
    v_fmac_f32 v7, v5, v24
    v_add_f32 v8, v65, v193
    v_add_f32 v9, v81, v209
    v_sub_f32 v193, v65, v193
    v_sub_f32 v209, v81, v209
    v_mfma_f32_32x32x16_bf16 v[224:239], v[40:43], a[16:19], v[224:239]
    v_mul_f32 v10, v8, v25
    v_mul_f32 v11, v8, v29
    v_fma_f32 v10, -v9, v29, v10
    v_fmac_f32 v11, v9, v25
    v_cvt_pk_bf16_f32 v48, v6, v10
    v_cvt_pk_bf16_f32 v56, v7, v11
    v_mfma_f32_32x32x16_bf16 v[240:255], v[40:43], a[0:3], v[240:255]
    v_add_f32 v4, v66, v194
    v_add_f32 v5, v82, v210
    v_sub_f32 v194, v66, v194
    v_sub_f32 v210, v82, v210
    v_mul_f32 v6, v4, v26
    v_mul_f32 v7, v4, v30
    v_mfma_f32_32x32x16_bf16 v[224:239], v[36:39], a[4:7], v[224:239]
    v_fma_f32 v6, -v5, v30, v6
    v_fmac_f32 v7, v5, v26
    v_add_f32 v8, v67, v195
    v_add_f32 v9, v83, v211
    v_sub_f32 v195, v67, v195
    v_sub_f32 v211, v83, v211
    v_mfma_f32_32x32x16_bf16 v[240:255], v[36:39], a[12:15], v[240:255]
    v_mul_f32 v10, v8, v27
    v_mul_f32 v11, v8, v31
    v_fma_f32 v10, -v9, v31, v10
    v_fmac_f32 v11, v9, v27
    v_cvt_pk_bf16_f32 v49, v6, v10
    v_cvt_pk_bf16_f32 v57, v7, v11
    v_mfma_f32_32x32x16_bf16 v[224:239], v[44:47], a[20:23], v[224:239]
    ds_read_b128 v[24:27], v22 offset:4096
    ds_read_b128 v[28:31], v22 offset:5120
    v_mfma_f32_32x32x16_bf16 v[240:255], v[44:47], a[4:7], v[240:255]
    v_pk_add_f32 v[4:5], v[68:69], v[196:197]
    v_pk_add_f32 v[6:7], v[84:85], v[212:213]
    v_pk_add_f32 v[196:197], v[68:69], v[196:197] neg_lo:[0,1] neg_hi:[0,1]
    v_pk_add_f32 v[212:213], v[84:85], v[212:213] neg_lo:[0,1] neg_hi:[0,1]
    s_waitcnt lgkmcnt(3)
    v_pk_mul_f32 v[8:9], v[4:5], v[104:105]
    s_waitcnt lgkmcnt(2)
    v_pk_mul_f32 v[10:11], v[4:5], v[108:109]
    v_pk_fma_f32 v[8:9], v[6:7], v[108:109], v[8:9] neg_lo:[1,0,0] neg_hi:[1,0,0]
    v_pk_fma_f32 v[10:11], v[6:7], v[104:105], v[10:11]
    v_cvt_pk_bf16_f32 v50, v8, v9
    v_cvt_pk_bf16_f32 v58, v10, v11
    v_pk_add_f32 v[4:5], v[70:71], v[198:199]
    v_pk_add_f32 v[6:7], v[86:87], v[214:215]
    v_pk_add_f32 v[198:199], v[70:71], v[198:199] neg_lo:[0,1] neg_hi:[0,1]
    v_pk_add_f32 v[214:215], v[86:87], v[214:215] neg_lo:[0,1] neg_hi:[0,1]
    v_pk_mul_f32 v[8:9], v[4:5], v[106:107]
    v_pk_mul_f32 v[10:11], v[4:5], v[110:111]
    v_pk_fma_f32 v[8:9], v[6:7], v[110:111], v[8:9] neg_lo:[1,0,0] neg_hi:[1,0,0]
    v_pk_fma_f32 v[10:11], v[6:7], v[106:107], v[10:11]
    v_cvt_pk_bf16_f32 v51, v8, v9
    v_cvt_pk_bf16_f32 v59, v10, v11
    ds_read_b128 v[104:107], v22 offset:6144
    ds_read_b128 v[108:111], v22 offset:7168
    v_pk_add_f32 v[4:5], v[72:73], v[200:201]
    v_pk_add_f32 v[6:7], v[88:89], v[216:217]
    v_pk_add_f32 v[200:201], v[72:73], v[200:201] neg_lo:[0,1] neg_hi:[0,1]
    v_pk_add_f32 v[216:217], v[88:89], v[216:217] neg_lo:[0,1] neg_hi:[0,1]
    s_waitcnt lgkmcnt(3)
    v_pk_mul_f32 v[8:9], v[4:5], v[24:25]
    s_waitcnt lgkmcnt(2)
    v_pk_mul_f32 v[10:11], v[4:5], v[28:29]
    v_pk_fma_f32 v[8:9], v[6:7], v[28:29], v[8:9] neg_lo:[1,0,0] neg_hi:[1,0,0]
    v_pk_fma_f32 v[10:11], v[6:7], v[24:25], v[10:11]
    v_cvt_pk_bf16_f32 v52, v8, v9
    v_cvt_pk_bf16_f32 v60, v10, v11
    v_pk_add_f32 v[4:5], v[74:75], v[202:203]
    v_pk_add_f32 v[6:7], v[90:91], v[218:219]
    v_pk_add_f32 v[202:203], v[74:75], v[202:203] neg_lo:[0,1] neg_hi:[0,1]
    v_pk_add_f32 v[218:219], v[90:91], v[218:219] neg_lo:[0,1] neg_hi:[0,1]
    v_pk_mul_f32 v[8:9], v[4:5], v[26:27]
    v_pk_mul_f32 v[10:11], v[4:5], v[30:31]
    v_pk_fma_f32 v[8:9], v[6:7], v[30:31], v[8:9] neg_lo:[1,0,0] neg_hi:[1,0,0]
    v_pk_fma_f32 v[10:11], v[6:7], v[26:27], v[10:11]
    v_cvt_pk_bf16_f32 v53, v8, v9
    v_cvt_pk_bf16_f32 v61, v10, v11
    ds_read_b128 v[24:27], v22 offset:8192
    ds_read_b128 v[28:31], v22 offset:9216
    v_pk_add_f32 v[4:5], v[76:77], v[204:205]
    v_pk_add_f32 v[6:7], v[92:93], v[220:221]
    v_pk_add_f32 v[204:205], v[76:77], v[204:205] neg_lo:[0,1] neg_hi:[0,1]
    v_pk_add_f32 v[220:221], v[92:93], v[220:221] neg_lo:[0,1] neg_hi:[0,1]
    s_waitcnt lgkmcnt(3)
    v_pk_mul_f32 v[8:9], v[4:5], v[104:105]
    s_waitcnt lgkmcnt(2)
    v_pk_mul_f32 v[10:11], v[4:5], v[108:109]
    v_pk_fma_f32 v[8:9], v[6:7], v[108:109], v[8:9] neg_lo:[1,0,0] neg_hi:[1,0,0]
    v_pk_fma_f32 v[10:11], v[6:7], v[104:105], v[10:11]
    v_cvt_pk_bf16_f32 v54, v8, v9
    v_cvt_pk_bf16_f32 v62, v10, v11
    v_pk_add_f32 v[4:5], v[78:79], v[206:207]
    v_pk_add_f32 v[6:7], v[94:95], v[222:223]
    v_pk_add_f32 v[206:207], v[78:79], v[206:207] neg_lo:[0,1] neg_hi:[0,1]
    v_pk_add_f32 v[222:223], v[94:95], v[222:223] neg_lo:[0,1] neg_hi:[0,1]
    v_pk_mul_f32 v[8:9], v[4:5], v[106:107]
    v_pk_mul_f32 v[10:11], v[4:5], v[110:111]
    v_pk_fma_f32 v[8:9], v[6:7], v[110:111], v[8:9] neg_lo:[1,0,0] neg_hi:[1,0,0]
    v_pk_fma_f32 v[10:11], v[6:7], v[106:107], v[10:11]
    v_cvt_pk_bf16_f32 v55, v8, v9
    v_cvt_pk_bf16_f32 v63, v10, v11
    ds_read_b128 v[104:107], v22 offset:10240
    ds_read_b128 v[108:111], v22 offset:11264
    v_mfma_f32_32x32x16_bf16 v[64:79], v[48:51], a[0:3], 0
    v_cvt_pk_bf16_f32 v128, v224, v240
    v_cvt_pk_bf16_f32 v130, v225, v241
    v_cvt_pk_bf16_f32 v132, v226, v242
    v_cvt_pk_bf16_f32 v134, v227, v243
    v_cvt_pk_bf16_f32 v136, v228, v244
    v_cvt_pk_bf16_f32 v138, v229, v245
    v_mfma_f32_32x32x16_bf16 v[80:95], v[48:51], a[8:11], 0
    v_cvt_pk_bf16_f32 v140, v230, v246
    v_cvt_pk_bf16_f32 v142, v231, v247
    v_cvt_pk_bf16_f32 v144, v232, v248
    v_cvt_pk_bf16_f32 v146, v233, v249
    v_cvt_pk_bf16_f32 v148, v234, v250
    v_cvt_pk_bf16_f32 v150, v235, v251
    v_mfma_f32_32x32x16_bf16 v[64:79], v[56:59], a[16:19], v[64:79]
    v_cvt_pk_bf16_f32 v152, v236, v252
    v_cvt_pk_bf16_f32 v154, v237, v253
    v_cvt_pk_bf16_f32 v156, v238, v254
    v_cvt_pk_bf16_f32 v158, v239, v255
    s_waitcnt lgkmcnt(3)
    v_mul_f32 v6, v160, v24
    s_waitcnt lgkmcnt(2)
    v_mul_f32 v7, v160, v28
    v_mfma_f32_32x32x16_bf16 v[80:95], v[56:59], a[0:3], v[80:95]
    v_fma_f32 v6, -v176, v28, v6
    v_fmac_f32 v7, v176, v24
    v_mul_f32 v10, v161, v25
    v_mul_f32 v11, v161, v29
    v_fma_f32 v10, -v177, v29, v10
    v_fmac_f32 v11, v177, v25
    v_mfma_f32_32x32x16_bf16 v[64:79], v[52:55], a[4:7], v[64:79]
    v_cvt_pk_bf16_f32 v32, v6, v10
    v_cvt_pk_bf16_f32 v40, v7, v11
    v_mul_f32 v6, v162, v26
    v_mul_f32 v7, v162, v30
    v_fma_f32 v6, -v178, v30, v6
    v_fmac_f32 v7, v178, v26
    v_mfma_f32_32x32x16_bf16 v[80:95], v[52:55], a[12:15], v[80:95]
    v_mul_f32 v10, v163, v27
    v_mul_f32 v11, v163, v31
    v_fma_f32 v10, -v179, v31, v10
    v_fmac_f32 v11, v179, v27
    v_cvt_pk_bf16_f32 v33, v6, v10
    v_cvt_pk_bf16_f32 v41, v7, v11
    v_mfma_f32_32x32x16_bf16 v[64:79], v[60:63], a[20:23], v[64:79]
    ds_read_b128 v[24:27], v22 offset:12288
    ds_read_b128 v[28:31], v22 offset:13312
    v_mfma_f32_32x32x16_bf16 v[80:95], v[60:63], a[4:7], v[80:95]
    s_waitcnt lgkmcnt(3)
    v_pk_mul_f32 v[8:9], v[164:165], v[104:105]
    s_waitcnt lgkmcnt(2)
    v_pk_mul_f32 v[10:11], v[164:165], v[108:109]
    v_pk_fma_f32 v[8:9], v[180:181], v[108:109], v[8:9] neg_lo:[1,0,0] neg_hi:[1,0,0]
    v_pk_fma_f32 v[10:11], v[180:181], v[104:105], v[10:11]
    v_cvt_pk_bf16_f32 v34, v8, v9
    v_cvt_pk_bf16_f32 v42, v10, v11
    v_pk_mul_f32 v[8:9], v[166:167], v[106:107]
    v_pk_mul_f32 v[10:11], v[166:167], v[110:111]
    v_pk_fma_f32 v[8:9], v[182:183], v[110:111], v[8:9] neg_lo:[1,0,0] neg_hi:[1,0,0]
    v_pk_fma_f32 v[10:11], v[182:183], v[106:107], v[10:11]
    v_cvt_pk_bf16_f32 v35, v8, v9
    v_cvt_pk_bf16_f32 v43, v10, v11
    ds_read_b128 v[104:107], v22 offset:14336
    ds_read_b128 v[108:111], v22 offset:15360
    v_cvt_pk_bf16_f32 v129, v64, v80
    v_cvt_pk_bf16_f32 v131, v65, v81
    v_cvt_pk_bf16_f32 v133, v66, v82
    v_cvt_pk_bf16_f32 v135, v67, v83
    v_cvt_pk_bf16_f32 v137, v68, v84
    v_cvt_pk_bf16_f32 v139, v69, v85
    v_cvt_pk_bf16_f32 v141, v70, v86
    v_cvt_pk_bf16_f32 v143, v71, v87
    v_cvt_pk_bf16_f32 v145, v72, v88
    v_cvt_pk_bf16_f32 v147, v73, v89
    v_cvt_pk_bf16_f32 v149, v74, v90
    v_cvt_pk_bf16_f32 v151, v75, v91
    v_cvt_pk_bf16_f32 v153, v76, v92
    v_cvt_pk_bf16_f32 v155, v77, v93
    v_cvt_pk_bf16_f32 v157, v78, v94
    v_cvt_pk_bf16_f32 v159, v79, v95
    s_mov_b32 s40, 0
    buffer_store_dwordx4 v[128:131], v23, s[24:27], s40 offen sc1
    s_mov_b32 s40, 57344
    buffer_store_dwordx4 v[132:135], v23, s[24:27], s40 offen sc1
    s_waitcnt lgkmcnt(3)
    v_pk_mul_f32 v[8:9], v[168:169], v[24:25]
    s_waitcnt lgkmcnt(2)
    v_pk_mul_f32 v[10:11], v[168:169], v[28:29]
    v_pk_fma_f32 v[8:9], v[184:185], v[28:29], v[8:9] neg_lo:[1,0,0] neg_hi:[1,0,0]
    v_pk_fma_f32 v[10:11], v[184:185], v[24:25], v[10:11]
    v_cvt_pk_bf16_f32 v36, v8, v9
    v_cvt_pk_bf16_f32 v44, v10, v11
    v_pk_mul_f32 v[8:9], v[170:171], v[26:27]
    v_pk_mul_f32 v[10:11], v[170:171], v[30:31]
    v_pk_fma_f32 v[8:9], v[186:187], v[30:31], v[8:9] neg_lo:[1,0,0] neg_hi:[1,0,0]
    v_pk_fma_f32 v[10:11], v[186:187], v[26:27], v[10:11]
    v_cvt_pk_bf16_f32 v37, v8, v9
    v_cvt_pk_bf16_f32 v45, v10, v11
    ds_read_b128 v[24:27], v22 offset:8192
    ds_read_b128 v[28:31], v22 offset:9216
    s_mov_b32 s40, 229376
    buffer_store_dwordx4 v[136:139], v23, s[24:27], s40 offen sc1
    s_waitcnt lgkmcnt(3)
    v_pk_mul_f32 v[8:9], v[172:173], v[104:105]
    s_waitcnt lgkmcnt(2)
    v_pk_mul_f32 v[10:11], v[172:173], v[108:109]
    v_pk_fma_f32 v[8:9], v[188:189], v[108:109], v[8:9] neg_lo:[1,0,0] neg_hi:[1,0,0]
    v_pk_fma_f32 v[10:11], v[188:189], v[104:105], v[10:11]
    v_cvt_pk_bf16_f32 v38, v8, v9
    v_cvt_pk_bf16_f32 v46, v10, v11
    v_pk_mul_f32 v[8:9], v[174:175], v[106:107]
    v_pk_mul_f32 v[10:11], v[174:175], v[110:111]
    v_pk_fma_f32 v[8:9], v[190:191], v[110:111], v[8:9] neg_lo:[1,0,0] neg_hi:[1,0,0]
    v_pk_fma_f32 v[10:11], v[190:191], v[106:107], v[10:11]
    v_cvt_pk_bf16_f32 v39, v8, v9
    v_cvt_pk_bf16_f32 v47, v10, v11
    ds_read_b128 v[104:107], v22 offset:10240
    ds_read_b128 v[108:111], v22 offset:11264
    s_mov_b32 s40, 286720
    buffer_store_dwordx4 v[140:143], v23, s[24:27], s40 offen sc1
    v_mfma_f32_32x32x16_bf16 v[224:239], v[32:35], a[0:3], 0
    s_waitcnt lgkmcnt(3)
    v_mul_f32 v6, v192, v24
    s_waitcnt lgkmcnt(2)
    v_mul_f32 v7, v192, v28
    v_fma_f32 v6, -v208, v28, v6
    v_fmac_f32 v7, v208, v24
    v_mul_f32 v10, v193, v25
    v_mul_f32 v11, v193, v29
    v_mfma_f32_32x32x16_bf16 v[240:255], v[32:35], a[8:11], 0
    v_fma_f32 v10, -v209, v29, v10
    v_fmac_f32 v11, v209, v25
    v_cvt_pk_bf16_f32 v48, v6, v10
    v_cvt_pk_bf16_f32 v56, v7, v11
    v_mul_f32 v6, v194, v26
    v_mul_f32 v7, v194, v30
    v_mfma_f32_32x32x16_bf16 v[224:239], v[40:43], a[16:19], v[224:239]
    s_mov_b32 s40, 458752
    buffer_store_dwordx4 v[144:147], v23, s[24:27], s40 offen sc1
    v_fma_f32 v6, -v210, v30, v6
    v_fmac_f32 v7, v210, v26
    v_mul_f32 v10, v195, v27
    v_mfma_f32_32x32x16_bf16 v[240:255], v[40:43], a[0:3], v[240:255]
    v_mul_f32 v11, v195, v31
    v_fma_f32 v10, -v211, v31, v10
    v_fmac_f32 v11, v211, v27
    v_cvt_pk_bf16_f32 v49, v6, v10
    v_cvt_pk_bf16_f32 v57, v7, v11
    v_mfma_f32_32x32x16_bf16 v[224:239], v[36:39], a[4:7], v[224:239]
    ds_read_b128 v[24:27], v22 offset:12288
    ds_read_b128 v[28:31], v22 offset:13312
    s_waitcnt lgkmcnt(3)
    v_mul_f32 v6, v196, v104
    s_waitcnt lgkmcnt(2)
    v_mul_f32 v7, v196, v108
    v_fma_f32 v6, -v212, v108, v6
    v_mfma_f32_32x32x16_bf16 v[240:255], v[36:39], a[12:15], v[240:255]
    s_mov_b32 s40, 516096
    buffer_store_dwordx4 v[148:151], v23, s[24:27], s40 offen sc1
    v_fmac_f32 v7, v212, v104
    v_mul_f32 v10, v197, v105
    v_mul_f32 v11, v197, v109
    v_mfma_f32_32x32x16_bf16 v[224:239], v[44:47], a[20:23], v[224:239]
    v_fma_f32 v10, -v213, v109, v10
    v_fmac_f32 v11, v213, v105
    v_cvt_pk_bf16_f32 v50, v6, v10
    v_cvt_pk_bf16_f32 v58, v7, v11
    v_mul_f32 v6, v198, v106
    v_mul_f32 v7, v198, v110
    v_mfma_f32_32x32x16_bf16 v[240:255], v[44:47], a[4:7], v[240:255]
    v_fma_f32 v6, -v214, v110, v6
    v_fmac_f32 v7, v214, v106
    v_mul_f32 v10, v199, v107
    v_mul_f32 v11, v199, v111
    v_fma_f32 v10, -v215, v111, v10
    v_fmac_f32 v11, v215, v107
    v_cvt_pk_bf16_f32 v51, v6, v10
    v_cvt_pk_bf16_f32 v59, v7, v11
    ds_read_b128 v[104:107], v22 offset:14336
    ds_read_b128 v[108:111], v22 offset:15360
    s_mov_b32 s40, 688128
    buffer_store_dwordx4 v[152:155], v23, s[24:27], s40 offen sc1
    s_waitcnt lgkmcnt(3)
    v_pk_mul_f32 v[8:9], v[200:201], v[24:25]
    s_waitcnt lgkmcnt(2)
    v_pk_mul_f32 v[10:11], v[200:201], v[28:29]
    v_pk_fma_f32 v[8:9], v[216:217], v[28:29], v[8:9] neg_lo:[1,0,0] neg_hi:[1,0,0]
    v_pk_fma_f32 v[10:11], v[216:217], v[24:25], v[10:11]
    v_cvt_pk_bf16_f32 v52, v8, v9
    v_cvt_pk_bf16_f32 v60, v10, v11
    v_pk_mul_f32 v[8:9], v[202:203], v[26:27]
    v_pk_mul_f32 v[10:11], v[202:203], v[30:31]
    v_pk_fma_f32 v[8:9], v[218:219], v[30:31], v[8:9] neg_lo:[1,0,0] neg_hi:[1,0,0]
    v_pk_fma_f32 v[10:11], v[218:219], v[26:27], v[10:11]
    v_cvt_pk_bf16_f32 v53, v8, v9
    v_cvt_pk_bf16_f32 v61, v10, v11
    s_mov_b32 s40, 745472
    buffer_store_dwordx4 v[156:159], v23, s[24:27], s40 offen sc1
    s_waitcnt lgkmcnt(1)
    v_pk_mul_f32 v[8:9], v[204:205], v[104:105]
    s_waitcnt lgkmcnt(0)
    v_pk_mul_f32 v[10:11], v[204:205], v[108:109]
    v_pk_fma_f32 v[8:9], v[220:221], v[108:109], v[8:9] neg_lo:[1,0,0] neg_hi:[1,0,0]
    v_pk_fma_f32 v[10:11], v[220:221], v[104:105], v[10:11]
    v_cvt_pk_bf16_f32 v54, v8, v9
    v_cvt_pk_bf16_f32 v62, v10, v11
    v_pk_mul_f32 v[8:9], v[206:207], v[106:107]
    v_pk_mul_f32 v[10:11], v[206:207], v[110:111]
    v_pk_fma_f32 v[8:9], v[222:223], v[110:111], v[8:9] neg_lo:[1,0,0] neg_hi:[1,0,0]
    v_pk_fma_f32 v[10:11], v[222:223], v[106:107], v[10:11]
    v_cvt_pk_bf16_f32 v55, v8, v9
    v_cvt_pk_bf16_f32 v63, v10, v11
    v_mfma_f32_32x32x16_bf16 v[64:79], v[48:51], a[0:3], 0
    v_cvt_pk_bf16_f32 v160, v224, v240
    v_cvt_pk_bf16_f32 v162, v225, v241
    v_cvt_pk_bf16_f32 v164, v226, v242
    v_cvt_pk_bf16_f32 v166, v227, v243
    v_cvt_pk_bf16_f32 v168, v228, v244
    v_cvt_pk_bf16_f32 v170, v229, v245
    v_mfma_f32_32x32x16_bf16 v[80:95], v[48:51], a[8:11], 0
    v_cvt_pk_bf16_f32 v172, v230, v246
    v_cvt_pk_bf16_f32 v174, v231, v247
    v_cvt_pk_bf16_f32 v176, v232, v248
    v_cvt_pk_bf16_f32 v178, v233, v249
    v_cvt_pk_bf16_f32 v180, v234, v250
    v_cvt_pk_bf16_f32 v182, v235, v251
    v_mfma_f32_32x32x16_bf16 v[64:79], v[56:59], a[16:19], v[64:79]
    v_cvt_pk_bf16_f32 v184, v236, v252
    v_cvt_pk_bf16_f32 v186, v237, v253
    v_cvt_pk_bf16_f32 v188, v238, v254
    v_cvt_pk_bf16_f32 v190, v239, v255
    v_mfma_f32_32x32x16_bf16 v[80:95], v[56:59], a[0:3], v[80:95]
    v_mfma_f32_32x32x16_bf16 v[64:79], v[52:55], a[4:7], v[64:79]
    v_mfma_f32_32x32x16_bf16 v[80:95], v[52:55], a[12:15], v[80:95]
    v_mfma_f32_32x32x16_bf16 v[64:79], v[60:63], a[20:23], v[64:79]
    v_mfma_f32_32x32x16_bf16 v[80:95], v[60:63], a[4:7], v[80:95]
    s_nop 11
    v_cvt_pk_bf16_f32 v161, v64, v80
    v_cvt_pk_bf16_f32 v163, v65, v81
    v_cvt_pk_bf16_f32 v165, v66, v82
    v_cvt_pk_bf16_f32 v167, v67, v83
    s_mov_b32 s40, 917504
    buffer_store_dwordx4 v[160:163], v23, s[24:27], s40 offen sc1
    s_mov_b32 s40, 974848
    buffer_store_dwordx4 v[164:167], v23, s[24:27], s40 offen sc1
    v_cvt_pk_bf16_f32 v169, v68, v84
L_stubA3:
    s_cbranch_execz L_retA
    v_cvt_pk_bf16_f32 v171, v69, v85
    v_cvt_pk_bf16_f32 v173, v70, v86
    v_cvt_pk_bf16_f32 v175, v71, v87
    v_cvt_pk_bf16_f32 v177, v72, v88
    v_cvt_pk_bf16_f32 v179, v73, v89
    v_cvt_pk_bf16_f32 v181, v74, v90
    v_cvt_pk_bf16_f32 v183, v75, v91
    v_cvt_pk_bf16_f32 v185, v76, v92
    v_cvt_pk_bf16_f32 v187, v77, v93
    v_cvt_pk_bf16_f32 v189, v78, v94
    v_cvt_pk_bf16_f32 v191, v79, v95
    s_mov_b32 s40, 1146880
    buffer_store_dwordx4 v[168:171], v23, s[24:27], s40 offen sc1
    s_mov_b32 s40, 1204224
    buffer_store_dwordx4 v[172:175], v23, s[24:27], s40 offen sc1
    s_mov_b32 s40, 1376256
    buffer_store_dwordx4 v[176:179], v23, s[24:27], s40 offen sc1
    s_mov_b32 s40, 1433600
    buffer_store_dwordx4 v[180:183], v23, s[24:27], s40 offen sc1
    s_mov_b32 s40, 1605632
    buffer_store_dwordx4 v[184:187], v23, s[24:27], s40 offen sc1
    s_mov_b32 s40, 1662976
    buffer_store_dwordx4 v[188:191], v23, s[24:27], s40 offen sc1
    s_waitcnt vmcnt(0)
    s_barrier
    buffer_store_byte v12, v13, s[24:27], s36 offen sc1
L_Aend:
    s_endpgm
L_slow6:
    s_mov_b32 s72, 200000
L_spin6:
    buffer_load_dword v20, v21, s[32:35], 0 offen sc1
    s_waitcnt vmcnt(0)
    v_cmp_ne_u32 vcc, 0x01010101, v20
    s_nop 1
    s_cbranch_vccz L_back6
    s_sub_u32 s72, s72, 1
    s_cmp_lg_u32 s72, 0
    s_cbranch_scc1 L_spin6
    s_branch L_back6
L_slow7:
    s_mov_b32 s72, 200000
L_spin7:
    s_load_dwordx4 s[44:47], s[24:25], s49 glc
    s_waitcnt lgkmcnt(0)
    s_or_b64 s[44:45], s[44:45], s[46:47]
    s_or_b32 s44, s44, s45
    s_cbranch_scc0 L_back7
    s_sub_u32 s72, s72, 1
    s_cmp_lg_u32 s72, 0
    s_cbranch_scc1 L_spin7
    s_branch L_back7
L_slow8:
    s_mov_b32 s72, 200000
L_spin8:
    s_load_dwordx4 s[44:47], s[24:25], s48 glc
    s_waitcnt lgkmcnt(0)
    s_or_b64 s[44:45], s[44:45], s[46:47]
    s_or_b32 s44, s44, s45
    s_cbranch_scc0 L_back8
    s_sub_u32 s72, s72, 1
    s_cmp_lg_u32 s72, 0
    s_cbranch_scc1 L_spin8
    s_branch L_back8
L_codeend:
.section .rodata,"a"
.p2align 6
.amdhsa_kernel parallel_sum__spectral_gfnet__glu_gated_swiglu__prompt_kernel
  .amdhsa_next_free_vgpr 512
  .amdhsa_next_free_sgpr 102
  .amdhsa_accum_offset 256
  .amdhsa_group_segment_fixed_size 0
  .amdhsa_kernarg_size 80
  .amdhsa_user_sgpr_count 2
  .amdhsa_user_sgpr_kernarg_segment_ptr 1
  .amdhsa_system_sgpr_workgroup_id_x 1
.end_amdhsa_kernel
```
